```python
import torch

def _softmax(x, axis=-1):
    return torch.softmax(x, dim=axis)
def _gelu(x):
    return torch.nn.functional.gelu(x, approximate="tanh")
def _silu(x):
    return torch.nn.functional.silu(x)
def _sigmoid(x):
    return torch.sigmoid(x)
def _layernorm(x, axis=-1, eps=1e-5):
    m = x.mean(dim=axis, keepdim=True)
    v = x.var(dim=axis, keepdim=True, unbiased=False)
    return (x - m) / torch.sqrt(v + eps)
def _scatter_add(tgt, idx, src, axis=0):
    return tgt.clone().index_add_(axis, idx, src)
def _segment_sum(src, seg, n):
    out = torch.zeros((n,) + src.shape[1:], dtype=src.dtype)
    return out.index_add_(0, seg, src)
def _pad(x, pw):
    flat = tuple(v for pair in reversed(pw) for v in pair)
    return torch.nn.functional.pad(x, flat)

kernel_name = 'gated_mix__ssm_conv_s4__ssm_conv_h3__prompt'

def setup_inputs():

    _w = (lambda a: (lambda t: t.to(torch.bfloat16) if t.is_floating_point() else t)(torch.as_tensor(a)))
    def _A_setup():
        B, L, D, N = 1, 2048, 512, 128
        A_re = -(lambda _x: torch.exp(torch.as_tensor(_x)))((lambda *s: torch.randn(*s, dtype=torch.bfloat16) * 6.4)(D, N))
        A_im = torch.pi * (lambda *s: torch.randn(*s, dtype=torch.bfloat16) * 0.05)(D, N)
        B_re = (lambda *s: torch.randn(*s, dtype=torch.bfloat16) * 0.1)(D, N)
        B_im = (lambda *s: torch.randn(*s, dtype=torch.bfloat16) * 0.1)(D, N)
        C_re = (lambda *s: torch.randn(*s, dtype=torch.bfloat16) * 0.1)(D, N)
        C_im = (lambda *s: torch.randn(*s, dtype=torch.bfloat16) * 0.1)(D, N)
        log_dt = (lambda *s: torch.randn(*s, dtype=torch.bfloat16) * 0.05)(D) * 0.5 - 4.0
        Dskip = (lambda *s: torch.randn(*s, dtype=torch.bfloat16) * 0.05)(D)
        return {
            "u": _w((lambda *s: torch.randn(*s, dtype=torch.bfloat16) * 0.05)(B, L, D)),
            "A_re": _w(A_re),
            "A_im": _w(A_im),
            "B_re": _w(B_re),
            "B_im": _w(B_im),
            "C_re": _w(C_re),
            "C_im": _w(C_im),
            "log_dt": _w(log_dt),
            "Dskip": _w(Dskip),
        }
    _A_in = _A_setup()

    def _B_setup():
        B, S, D = 1, 2048, 512
        ks = 4
        return {
            "q": _w((lambda *s: torch.randn(*s, dtype=torch.bfloat16) * 0.05)(B, S, D)),
            "k": _w((lambda *s: torch.randn(*s, dtype=torch.bfloat16) * 0.4)(B, S, D)),
            "v": _w((lambda *s: torch.randn(*s, dtype=torch.bfloat16) * 0.4)(B, S, D)),
            "shift_k": _w((lambda *s: torch.randn(*s, dtype=torch.bfloat16) * 0.4)(D, ks) * 0.5),
            "ssm_k": _w((lambda *s: torch.randn(*s, dtype=torch.bfloat16) * 0.4)(D, S) * (1.0 / S ** 0.5)),
            "ssm_D": _w((lambda *s: torch.randn(*s, dtype=torch.bfloat16) * 0.4)(D)),
        }
    _B_in = _B_setup()

    return {
        "A_u": _A_in["u"],
        "A_A_re": _A_in["A_re"],
        "A_A_im": _A_in["A_im"],
        "A_B_re": _A_in["B_re"],
        "A_B_im": _A_in["B_im"],
        "A_C_re": _A_in["C_re"],
        "A_C_im": _A_in["C_im"],
        "A_log_dt": _A_in["log_dt"],
        "A_Dskip": _A_in["Dskip"],
        "B_q": _B_in["q"],
        "B_k": _B_in["k"],
        "B_v": _B_in["v"],
        "B_shift_k": _B_in["shift_k"],
        "B_ssm_k": _B_in["ssm_k"],
        "B_ssm_D": _B_in["ssm_D"],
        "gate_w": _w((lambda *s: torch.randn(*s, dtype=torch.bfloat16) * 0.05)(512) * 16.0),
    }

def reference(A_u, A_A_re, A_A_im, A_B_re, A_B_im, A_C_re, A_C_im, A_log_dt, A_Dskip, B_q, B_k, B_v, B_shift_k, B_ssm_k, B_ssm_D, gate_w):
    def _A_ref(u, A_re, A_im, B_re, B_im, C_re, C_im, log_dt, Dskip):
        Bsz, L, D = u.shape
        dt = torch.exp(log_dt)[:, None]
        A = A_re + 1j * A_im
        Bc = B_re + 1j * B_im
        Cc = C_re + 1j * C_im
        logdA = dt * A
        dB = dt * Bc
        l = (lambda x, dt: x.to(dt))(torch.arange(L), A_re.dtype)
        P = torch.exp(logdA[:, :, None] * l[None, None, :])
        K = torch.einsum("dn,dnl,dn->dl", Cc, P, dB).real
        L2 = 2 * L
        Kp = _pad(K, ((0, 0), (0, L)))
        up = (lambda x, *d: x.permute(*d))(u, 0, 2, 1)
        up = _pad(up, ((0, 0), (0, 0), (0, L)))
        Kf = (lambda x, axes=(-2,-1): torch.fft.rfft2(x.float(), dim=axes))(Kp[:, None, :], axes=(-2, -1))
        Uf = (lambda x, axes=(-2,-1): torch.fft.rfft2(x.float(), dim=axes))(up[:, :, None, :], axes=(-2, -1))
        Yf = Uf * Kf[None, :, :, :]
        y = (lambda x, s, axes=(-2,-1): torch.fft.irfft2(x, s=s, dim=axes).to(torch.bfloat16))(Yf, (1, L2), axes=(-2, -1))[:, :, 0, :L]
        y = (lambda x, *d: x.permute(*d))(y, 0, 2, 1) + u * Dskip[None, None, :]
        return y

    def _B_ref(q, k, v, shift_k, ssm_k, ssm_D):
        B, S, D = q.shape
        ks = shift_k.shape[-1]
        k_pad = _pad(k, ((0, 0), (ks - 1, 0), (0, 0)))
        k_shift = torch.zeros_like(k)
        for t in range(ks):
            k_shift = k_shift + k_pad[:, t:t + S, :] * shift_k[:, ks - 1 - t][None, None, :]
        kv = k_shift * v
        L = 2 * S
        kv_pad = _pad(kv, ((0, 0), (0, S), (0, 0)))
        kf_pad = _pad(ssm_k, ((0, 0), (0, S)))
        kv_f = (lambda x, axes=(-2,-1): torch.fft.rfft2(x.float(), dim=axes))(kv_pad[:, None, :, :], axes=(1, 2))
        kf_f = (lambda x, axes=(-2,-1): torch.fft.rfft2(x.float(), dim=axes))(kf_pad[:, None, :], axes=(1, 2))
        kf_f = (lambda x, *d: x.permute(*d))(kf_f, 1, 2, 0)
        y_f = kv_f * kf_f[None, :, :, :]
        y = (lambda x, s, axes=(-2,-1): torch.fft.irfft2(x, s=s, dim=axes).to(torch.bfloat16))(y_f, (1, L), axes=(1, 2))[:, 0, :S, :]
        y = y + kv * ssm_D[None, None, :]
        return q * y

    x = A_u
    g = _sigmoid((x * gate_w).sum(-1, keepdims=True))
    a = _A_ref(x, A_A_re, A_A_im, A_B_re, A_B_im, A_C_re, A_C_im, A_log_dt, A_Dskip)
    b = _B_ref(x, B_k, B_v, B_shift_k, B_ssm_k, B_ssm_D)
    return g * a + (1 - g) * b
```

```asm
; @launch grid=(256,1,1) block=(512,1,1) lds=107136
.amdgcn_target "amdgcn-amd-amdhsa--gfx950"
.text
.globl gated_mix__ssm_conv_s4__ssm_conv_h3__prompt_kernel
.p2align 8
.type gated_mix__ssm_conv_s4__ssm_conv_h3__prompt_kernel,@function
gated_mix__ssm_conv_s4__ssm_conv_h3__prompt_kernel:
  s_cmp_ge_u32 s2, 256
  s_cbranch_scc1 L_end
  s_load_dwordx16 s[16:31], s[0:1], 0
  s_load_dwordx16 s[32:47], s[0:1], 64
  s_load_dwordx4 s[48:51], s[0:1], 128
  s_load_dwordx2 s[52:53], s[0:1], 144
  s_getpc_b64 s[8:9]
L_pc:
  v_lshlrev_b32 v4, 4, v0
  global_load_dwordx4 v[100:103], v4, s[8:9]
  v_add_u32 v4, 8192, v4
  v_min_u32 v4, L_end-L_pc-16, v4
  global_load_dwordx4 v[104:107], v4, s[8:9]
  v_lshrrev_b32 v4, 6, v0
  v_and_b32 v1, 63, v0
  v_readfirstlane_b32 s3, v4
  v_and_b32 v2, 15, v1
  v_lshrrev_b32 v3, 4, v1
  s_and_b32 s4, s2, 7
  s_lshr_b32 s5, s2, 3
  s_and_b32 s8, s3, 2
  s_and_b32 s9, s3, 1
  s_lshl_b32 s10, s5, 6
  s_lshl_b32 s8, s8, 4
  s_add_u32 s10, s10, s8
  s_lshl_b32 s11, s4, 6
  s_lshl_b32 s9, s9, 5
  s_add_u32 s11, s11, s9
  s_lshl_b32 s12, s10, 10
  s_lshl_b32 s13, s11, 1
  s_add_u32 s12, s12, s13
  v_lshlrev_b32 v5, 13, v3
  v_lshl_add_u32 v5, v2, 2, v5
  v_add_u32 v5, s12, v5
  v_add_u32 v6, 4096, v5
  s_lshl_b32 s6, s4, 6
  s_lshl_b32 s8, s5, 1
  s_add_u32 s6, s6, s8
  s_lshr_b32 s8, s3, 2
  s_add_u32 s8, s8, s6
  s_and_b32 s9, s3, 3
  s_lshl_b32 s12, s8, 8
  s_lshl_b32 s13, s9, 6
  s_add_u32 s12, s12, s13
  v_and_b32 v8, 31, v1
  v_lshlrev_b32 v8, 1, v8
  v_add_u32 v8, s12, v8
  s_lshl_b32 s13, s8, 1
  v_mov_b32 v9, s13
  v_subrev_u32 v7, 3072, v5
  s_lshl_b32 s13, s11, 3
  v_lshlrev_b32 v4, 4, v2
  v_add_u32 v4, s13, v4
  s_waitcnt lgkmcnt(0)
  s_cmp_ge_u32 s3, 4
  s_cbranch_scc1 L_uload
  s_mov_b32 s12, s36
  s_and_b32 s13, s37, 0xffff
  s_mov_b32 s14, 0x200000
  s_mov_b32 s15, 0x00020000
  global_load_dwordx4 v[30:33], v4, s[40:41]
  buffer_load_dword v10, v7, s[12:15], 0 offen offset:0
  buffer_load_dword v11, v7, s[12:15], 0 offen offset:1024
  buffer_load_dword v12, v7, s[12:15], 0 offen offset:2048
  buffer_load_dword v13, v5, s[12:15], 0 offen offset:0
  buffer_load_dword v14, v5, s[12:15], 0 offen offset:1024
  buffer_load_dword v15, v5, s[12:15], 0 offen offset:2048
  buffer_load_dword v16, v5, s[12:15], 0 offen offset:3072
  buffer_load_dword v17, v6, s[12:15], 0 offen offset:0
  buffer_load_dword v18, v6, s[12:15], 0 offen offset:1024
  buffer_load_dword v19, v6, s[12:15], 0 offen offset:2048
  buffer_load_dword v20, v6, s[12:15], 0 offen offset:3072
  global_load_dword v21, v5, s[38:39] offset:0
  global_load_dword v22, v5, s[38:39] offset:1024
  global_load_dword v23, v5, s[38:39] offset:2048
  global_load_dword v24, v5, s[38:39] offset:3072
  global_load_dword v25, v6, s[38:39] offset:0
  global_load_dword v26, v6, s[38:39] offset:1024
  global_load_dword v27, v6, s[38:39] offset:2048
  global_load_dword v28, v6, s[38:39] offset:3072
  s_lshl_b32 s8, s2, 7
  s_add_u32 s8, s8, 0x700000
  v_mov_b32 v242, s8
  v_mov_b32 v243, 0
  global_load_dwordx2 v[240:241], v242, s[52:53] sc1
  global_load_ushort v238, v9, s[30:31]
  global_load_ushort v232, v8, s[18:19]
  global_load_ushort v233, v8, s[20:21]
  global_load_ushort v234, v8, s[22:23]
  global_load_ushort v235, v8, s[24:25]
  global_load_ushort v236, v8, s[26:27]
  global_load_ushort v237, v8, s[28:29]
  s_branch L_common
L_uload:
  global_load_dword v10, v5, s[16:17] offset:0
  global_load_dword v11, v5, s[16:17] offset:1024
  global_load_dword v12, v5, s[16:17] offset:2048
  global_load_dword v13, v5, s[16:17] offset:3072
  global_load_dword v14, v6, s[16:17] offset:0
  global_load_dword v15, v6, s[16:17] offset:1024
  global_load_dword v16, v6, s[16:17] offset:2048
  global_load_dword v17, v6, s[16:17] offset:3072
  global_load_ushort v238, v9, s[30:31]
  global_load_ushort v232, v8, s[18:19]
  global_load_ushort v233, v8, s[20:21]
  global_load_ushort v234, v8, s[22:23]
  global_load_ushort v235, v8, s[24:25]
  global_load_ushort v236, v8, s[26:27]
  global_load_ushort v237, v8, s[28:29]
  s_lshl_b32 s8, s2, 3
  s_lshl_b32 s12, s9, 1
  s_add_u32 s35, s8, s12
  s_lshl_b32 s8, s35, 10
  v_lshlrev_b32 v241, 4, v1
  v_add_u32 v243, s8, v241
  s_lshr_b32 s8, s9, 1
  s_add_u32 s8, s8, s6
  s_lshl_b32 s8, s8, 12
  s_and_b32 s12, s9, 1
  s_lshl_b32 s12, s12, 11
  s_add_u32 s8, s8, s12
  v_add_u32 v242, s8, v241
  v_mov_b32 v44, 0
  v_mov_b32 v45, 0
  v_mov_b32 v46, 0
  v_mov_b32 v47, 0
  v_mov_b32 v42, 24576
  ds_write_b128 v42, v[44:47]
  ds_write_b128 v42, v[44:47] offset:16
  s_mul_i32 s12, s9, 4224
  s_add_u32 s12, s12, 90240
  v_add_u32 v42, s12, v241
  s_mov_b64 exec, 0xf
  ds_write_b128 v42, v[44:47]
  s_mov_b64 exec, -1
  s_or_b32 s12, s9, 1
  s_mul_i32 s12, s12, 4224
  s_and_b32 s13, s9, 1
  s_lshl_b32 s13, s13, 11
  s_add_u32 s12, s12, s13
  s_add_u32 s12, s12, 90304
  v_add_u32 v240, s12, v241
L_common:
  s_bfe_u32 s8, s3, 0x10001
  s_add_u32 s8, s8, s6
  s_and_b32 s9, s3, 1
  s_lshl_b32 s8, s8, 12
  s_lshl_b32 s9, s9, 21
  s_add_u32 s9, s9, s8
  s_add_u32 s36, s52, s9
  s_addc_u32 s37, s53, 0
  s_and_b32 s37, s37, 0xffff
  s_mov_b32 s38, 4096
  s_mov_b32 s39, 0x00020000
  v_lshlrev_b32 v202, 4, v1
  v_add_u32 v203, 16, v202
  s_mov_b32 s7, 0xffff0000
  s_mov_b32 s54, 0xffff
  s_mov_b32 s55, 0x3f803f80
  s_mov_b32 s56, 0x05040100
  s_mov_b32 s57, 0x07060302
  s_mul_i32 s8, s3, 2560
  s_add_u32 s8, s8, 28800
  v_mul_u32_u24 v4, 160, v2
  v_lshlrev_b32 v42, 4, v3
  v_sub_u32 v4, v4, v42
  v_add3_u32 v4, v4, s8, 48
  v_lshrrev_b32 v42, 2, v1
  v_and_b32 v43, 3, v1
  v_mul_u32_u24 v5, 80, v42
  v_lshl_add_u32 v5, v43, 4, v5
  v_add_u32 v5, s8, v5
  s_lshl_b32 s8, s11, 12
  s_sub_u32 s9, 2016, s10
  s_lshl_b32 s9, s9, 1
  s_add_u32 s8, s8, s9
  s_cmp_lt_u32 s3, 4
  s_cselect_b32 s9, 0x200000, 0
  s_add_u32 s8, s8, s9
  v_lshlrev_b32 v42, 12, v42
  v_lshl_add_u32 v42, v43, 4, v42
  v_add_u32 v6, s8, v42
  v_add_u32 v7, 0x10000, v6
  v_mov_b32 v217, 24704
  s_waitcnt lgkmcnt(0)
  s_barrier
  s_cmp_ge_u32 s3, 4
  s_cbranch_scc1 L_uphase
  s_mov_b64 exec, 0
  s_cmp_eq_u32 s3, 0
  s_cbranch_scc1 L_kv0
  s_cmp_eq_u32 s3, 1
  s_cbranch_scc1 L_kv1
  s_cmp_eq_u32 s3, 2
  s_cbranch_scc1 L_kv2
  s_cmp_eq_u32 s3, 3
  s_cbranch_scc1 L_kv3
L_warm_ret:
  s_mov_b64 exec, -1
  s_cmp_ge_u32 s3, 4
  s_cbranch_scc1 L_uphase
  s_setprio 2
  s_waitcnt vmcnt(16)
L_kv0:
  v_and_b32 v34, s54, v30
  v_lshrrev_b32 v35, 16, v30
  v_and_b32 v36, s54, v31
  v_lshrrev_b32 v37, 16, v31
  v_lshlrev_b32 v38, 16, v32
  v_and_b32 v39, s7, v32
  v_lshlrev_b32 v40, 16, v33
  v_and_b32 v41, s7, v33
  v_dot2_f32_bf16 v44, v10, v37, 0
  v_dot2_f32_bf16 v52, v11, v36, 0
  v_dot2_f32_bf16 v45, v10, v41, 0
  v_dot2_f32_bf16 v53, v11, v40, 0
  v_dot2_f32_bf16 v46, v11, v37, 0
  v_dot2_f32_bf16 v54, v12, v36, 0
  v_dot2_f32_bf16 v47, v11, v41, 0
  v_dot2_f32_bf16 v55, v12, v40, 0
  v_dot2_f32_bf16 v48, v12, v37, 0
  v_dot2_f32_bf16 v56, v13, v36, 0
  v_dot2_f32_bf16 v49, v12, v41, 0
  v_dot2_f32_bf16 v57, v13, v40, 0
  v_dot2_f32_bf16 v50, v13, v37, 0
  v_dot2_f32_bf16 v58, v14, v36, 0
  v_dot2_f32_bf16 v51, v13, v41, 0
  v_dot2_f32_bf16 v59, v14, v40, 0
  v_dot2_f32_bf16 v60, v12, v35, 0
  v_cvt_pk_bf16_f32 v76, v44, v52
  v_dot2_f32_bf16 v61, v12, v39, 0
  v_cvt_pk_bf16_f32 v77, v45, v53
  v_dot2_f32_bf16 v62, v13, v35, 0
  v_cvt_pk_bf16_f32 v78, v46, v54
  v_dot2_f32_bf16 v63, v13, v39, 0
  v_cvt_pk_bf16_f32 v79, v47, v55
  v_dot2_f32_bf16 v64, v14, v35, 0
  v_cvt_pk_bf16_f32 v80, v48, v56
  v_dot2_f32_bf16 v65, v14, v39, 0
  v_cvt_pk_bf16_f32 v81, v49, v57
  v_dot2_f32_bf16 v66, v15, v35, 0
  v_cvt_pk_bf16_f32 v82, v50, v58
  v_dot2_f32_bf16 v67, v15, v39, 0
  v_cvt_pk_bf16_f32 v83, v51, v59
  v_dot2_f32_bf16 v68, v13, v34, 0
  v_dot2_f32_bf16 v44, v76, s55, 0
  v_dot2_f32_bf16 v69, v13, v38, 0
  v_dot2_f32_bf16 v45, v77, s55, 0
  v_dot2_f32_bf16 v70, v14, v34, 0
  v_dot2_f32_bf16 v46, v78, s55, 0
  v_dot2_f32_bf16 v71, v14, v38, 0
  v_dot2_f32_bf16 v47, v79, s55, 0
  v_dot2_f32_bf16 v72, v15, v34, 0
  v_dot2_f32_bf16 v48, v80, s55, 0
  v_dot2_f32_bf16 v73, v15, v38, 0
  v_dot2_f32_bf16 v49, v81, s55, 0
  v_dot2_f32_bf16 v74, v16, v34, 0
  v_dot2_f32_bf16 v50, v82, s55, 0
  v_dot2_f32_bf16 v75, v16, v38, 0
  v_dot2_f32_bf16 v51, v83, s55, 0
  s_cbranch_execz L_warm_ret
L_kv1:
  v_cvt_pk_bf16_f32 v76, v44, v60
  v_cvt_pk_bf16_f32 v77, v45, v61
  v_cvt_pk_bf16_f32 v78, v46, v62
  v_cvt_pk_bf16_f32 v79, v47, v63
  v_cvt_pk_bf16_f32 v80, v48, v64
  v_cvt_pk_bf16_f32 v81, v49, v65
  v_cvt_pk_bf16_f32 v82, v50, v66
  v_cvt_pk_bf16_f32 v83, v51, v67
  v_dot2_f32_bf16 v44, v76, s55, 0
  v_dot2_f32_bf16 v45, v77, s55, 0
  v_dot2_f32_bf16 v46, v78, s55, 0
  v_dot2_f32_bf16 v47, v79, s55, 0
  v_dot2_f32_bf16 v48, v80, s55, 0
  v_dot2_f32_bf16 v49, v81, s55, 0
  v_dot2_f32_bf16 v50, v82, s55, 0
  v_dot2_f32_bf16 v51, v83, s55, 0
  v_cvt_pk_bf16_f32 v76, v44, v68
  v_cvt_pk_bf16_f32 v77, v45, v69
  v_cvt_pk_bf16_f32 v78, v46, v70
  v_cvt_pk_bf16_f32 v79, v47, v71
  v_cvt_pk_bf16_f32 v80, v48, v72
  v_cvt_pk_bf16_f32 v81, v49, v73
  v_cvt_pk_bf16_f32 v82, v50, v74
  v_cvt_pk_bf16_f32 v83, v51, v75
  v_dot2_f32_bf16 v44, v76, s55, 0
  v_dot2_f32_bf16 v45, v77, s55, 0
  v_dot2_f32_bf16 v46, v78, s55, 0
  v_dot2_f32_bf16 v47, v79, s55, 0
  v_dot2_f32_bf16 v48, v80, s55, 0
  v_dot2_f32_bf16 v49, v81, s55, 0
  v_dot2_f32_bf16 v50, v82, s55, 0
  v_dot2_f32_bf16 v51, v83, s55, 0
  s_cbranch_execz L_kvskipw
  s_waitcnt vmcnt(8)
L_kvskipw:
  v_and_b32 v52, s54, v21
  v_and_b32 v53, s7, v21
  v_and_b32 v54, s54, v22
  v_and_b32 v55, s7, v22
  v_and_b32 v56, s54, v23
  v_and_b32 v57, s7, v23
  v_and_b32 v58, s54, v24
  v_and_b32 v59, s7, v24
  v_cvt_pk_bf16_f32 v76, v44, v45
  v_cvt_pk_bf16_f32 v77, v46, v47
  v_cvt_pk_bf16_f32 v78, v48, v49
  v_cvt_pk_bf16_f32 v79, v50, v51
  v_dot2_f32_bf16 v60, v76, v52, 0
  v_dot2_f32_bf16 v61, v76, v53, 0
  v_dot2_f32_bf16 v62, v77, v54, 0
  v_dot2_f32_bf16 v63, v77, v55, 0
  v_dot2_f32_bf16 v64, v78, v56, 0
  v_dot2_f32_bf16 v65, v78, v57, 0
  v_dot2_f32_bf16 v66, v79, v58, 0
  v_dot2_f32_bf16 v67, v79, v59, 0
  s_nop 1
  v_cvt_pk_bf16_f32 v88, v60, v61
  v_cvt_pk_bf16_f32 v89, v62, v63
  v_cvt_pk_bf16_f32 v90, v64, v65
  v_cvt_pk_bf16_f32 v91, v66, v67
  s_cbranch_execz L_warm_ret
L_kv2:
  v_dot2_f32_bf16 v44, v14, v37, 0
  v_dot2_f32_bf16 v52, v15, v36, 0
  v_dot2_f32_bf16 v45, v14, v41, 0
  v_dot2_f32_bf16 v53, v15, v40, 0
  v_dot2_f32_bf16 v46, v15, v37, 0
  v_dot2_f32_bf16 v54, v16, v36, 0
  v_dot2_f32_bf16 v47, v15, v41, 0
  v_dot2_f32_bf16 v55, v16, v40, 0
  v_dot2_f32_bf16 v48, v16, v37, 0
  v_dot2_f32_bf16 v56, v17, v36, 0
  v_dot2_f32_bf16 v49, v16, v41, 0
  v_dot2_f32_bf16 v57, v17, v40, 0
  v_dot2_f32_bf16 v50, v17, v37, 0
  v_dot2_f32_bf16 v58, v18, v36, 0
  v_dot2_f32_bf16 v51, v17, v41, 0
  v_dot2_f32_bf16 v59, v18, v40, 0
  v_dot2_f32_bf16 v60, v16, v35, 0
  v_cvt_pk_bf16_f32 v76, v44, v52
  v_dot2_f32_bf16 v61, v16, v39, 0
  v_cvt_pk_bf16_f32 v77, v45, v53
  v_dot2_f32_bf16 v62, v17, v35, 0
  v_cvt_pk_bf16_f32 v78, v46, v54
  v_dot2_f32_bf16 v63, v17, v39, 0
  v_cvt_pk_bf16_f32 v79, v47, v55
  v_dot2_f32_bf16 v64, v18, v35, 0
  v_cvt_pk_bf16_f32 v80, v48, v56
  v_dot2_f32_bf16 v65, v18, v39, 0
  v_cvt_pk_bf16_f32 v81, v49, v57
  v_dot2_f32_bf16 v66, v19, v35, 0
  v_cvt_pk_bf16_f32 v82, v50, v58
  v_dot2_f32_bf16 v67, v19, v39, 0
  v_cvt_pk_bf16_f32 v83, v51, v59
  v_dot2_f32_bf16 v68, v17, v34, 0
  v_dot2_f32_bf16 v44, v76, s55, 0
  v_dot2_f32_bf16 v69, v17, v38, 0
  v_dot2_f32_bf16 v45, v77, s55, 0
  v_dot2_f32_bf16 v70, v18, v34, 0
  v_dot2_f32_bf16 v46, v78, s55, 0
  v_dot2_f32_bf16 v71, v18, v38, 0
  v_dot2_f32_bf16 v47, v79, s55, 0
  v_dot2_f32_bf16 v72, v19, v34, 0
  v_dot2_f32_bf16 v48, v80, s55, 0
  v_dot2_f32_bf16 v73, v19, v38, 0
  v_dot2_f32_bf16 v49, v81, s55, 0
  v_dot2_f32_bf16 v74, v20, v34, 0
  v_dot2_f32_bf16 v50, v82, s55, 0
  v_dot2_f32_bf16 v75, v20, v38, 0
  v_dot2_f32_bf16 v51, v83, s55, 0
  s_cbranch_execz L_warm_ret
L_kv3:
  v_cvt_pk_bf16_f32 v76, v44, v60
  v_cvt_pk_bf16_f32 v77, v45, v61
  v_cvt_pk_bf16_f32 v78, v46, v62
  v_cvt_pk_bf16_f32 v79, v47, v63
  v_cvt_pk_bf16_f32 v80, v48, v64
  v_cvt_pk_bf16_f32 v81, v49, v65
  v_cvt_pk_bf16_f32 v82, v50, v66
  v_cvt_pk_bf16_f32 v83, v51, v67
  v_dot2_f32_bf16 v44, v76, s55, 0
  v_dot2_f32_bf16 v45, v77, s55, 0
  v_dot2_f32_bf16 v46, v78, s55, 0
  v_dot2_f32_bf16 v47, v79, s55, 0
  v_dot2_f32_bf16 v48, v80, s55, 0
  v_dot2_f32_bf16 v49, v81, s55, 0
  v_dot2_f32_bf16 v50, v82, s55, 0
  v_dot2_f32_bf16 v51, v83, s55, 0
  v_cvt_pk_bf16_f32 v76, v44, v68
  v_cvt_pk_bf16_f32 v77, v45, v69
  v_cvt_pk_bf16_f32 v78, v46, v70
  v_cvt_pk_bf16_f32 v79, v47, v71
  v_cvt_pk_bf16_f32 v80, v48, v72
  v_cvt_pk_bf16_f32 v81, v49, v73
  v_cvt_pk_bf16_f32 v82, v50, v74
  v_cvt_pk_bf16_f32 v83, v51, v75
  v_dot2_f32_bf16 v44, v76, s55, 0
  v_dot2_f32_bf16 v45, v77, s55, 0
  v_dot2_f32_bf16 v46, v78, s55, 0
  v_dot2_f32_bf16 v47, v79, s55, 0
  v_dot2_f32_bf16 v48, v80, s55, 0
  v_dot2_f32_bf16 v49, v81, s55, 0
  v_dot2_f32_bf16 v50, v82, s55, 0
  v_dot2_f32_bf16 v51, v83, s55, 0
  v_and_b32 v52, s54, v25
  v_and_b32 v53, s7, v25
  v_and_b32 v54, s54, v26
  v_and_b32 v55, s7, v26
  v_and_b32 v56, s54, v27
  v_and_b32 v57, s7, v27
  v_and_b32 v58, s54, v28
  v_and_b32 v59, s7, v28
  v_cvt_pk_bf16_f32 v76, v44, v45
  v_cvt_pk_bf16_f32 v77, v46, v47
  v_cvt_pk_bf16_f32 v78, v48, v49
  v_cvt_pk_bf16_f32 v79, v50, v51
  v_dot2_f32_bf16 v60, v76, v52, 0
  v_dot2_f32_bf16 v61, v76, v53, 0
  v_dot2_f32_bf16 v62, v77, v54, 0
  v_dot2_f32_bf16 v63, v77, v55, 0
  v_dot2_f32_bf16 v64, v78, v56, 0
  v_dot2_f32_bf16 v65, v78, v57, 0
  v_dot2_f32_bf16 v66, v79, v58, 0
  v_dot2_f32_bf16 v67, v79, v59, 0
  s_nop 1
  v_cvt_pk_bf16_f32 v92, v60, v61
  v_cvt_pk_bf16_f32 v93, v62, v63
  v_cvt_pk_bf16_f32 v94, v64, v65
  v_cvt_pk_bf16_f32 v95, v66, v67
  s_cbranch_execz L_warm_ret
  v_perm_b32 v44, v94, v95, s56
  v_perm_b32 v48, v94, v95, s57
  v_perm_b32 v45, v92, v93, s56
  v_perm_b32 v49, v92, v93, s57
  v_perm_b32 v46, v90, v91, s56
  v_perm_b32 v50, v90, v91, s57
  v_perm_b32 v47, v88, v89, s56
  v_perm_b32 v51, v88, v89, s57
  ds_write_b128 v4, v[44:47]
  ds_write_b128 v4, v[48:51] offset:80
  ds_read_b128 v[52:55], v5
  ds_read_b128 v[56:59], v5 offset:1280
  s_waitcnt vmcnt(7)
  v_add_u32 v240, 1, v240
  v_add_u32 v241, 8, v241
  v_mov_b32 v10, 24584
  ds_write_b32 v10, v241
  s_waitcnt lgkmcnt(2)
  global_store_dwordx4 v6, v[52:55], s[52:53] sc1
  s_waitcnt lgkmcnt(1)
  global_store_dwordx4 v7, v[56:59], s[52:53] sc1
  s_setprio 0
  s_mul_i32 s8, s3, 4224
  s_add_u32 s8, s8, 90244
  v_lshlrev_b32 v192, 2, v2
  v_lshl_add_u32 v192, v3, 4, v192
  v_add_u32 v192, s8, v192
  v_add_u32 v193, 512, v192
  v_add_u32 v194, 1024, v192
  v_add_u32 v195, 1536, v192
  v_add_u32 v196, 2048, v192
  v_add_u32 v197, 2560, v192
  v_add_u32 v198, 3072, v192
  v_add_u32 v199, 3584, v192
  s_mul_i32 s8, s3, 9216
  s_add_u32 s8, s8, 53376
  v_and_b32 v42, 1, v2
  v_lshrrev_b32 v43, 1, v2
  v_sub_u32 v42, 1, v42
  v_mul_u32_u24 v42, 4640, v42
  v_lshlrev_b32 v43, 6, v43
  v_sub_u32 v42, v42, v43
  v_lshl_add_u32 v42, v3, 4, v42
  v_add_u32 v42, 448, v42
  v_add_u32 v201, s8, v42
  v_lshlrev_b32 v202, 4, v1
  v_add_u32 v200, s8, v202
  v_mov_b32 v160, 0
  v_mov_b32 v161, 0
  v_mov_b32 v162, 0
  v_mov_b32 v163, 0
  v_mov_b32 v164, 0
  v_mov_b32 v165, 0
  v_mov_b32 v166, 0
  v_mov_b32 v167, 0
  v_mov_b32 v168, 0
  v_mov_b32 v169, 0
  v_mov_b32 v170, 0
  v_mov_b32 v171, 0
  v_mov_b32 v172, 0
  v_mov_b32 v173, 0
  v_mov_b32 v174, 0
  v_mov_b32 v175, 0
  v_mov_b32 v176, 0
  v_mov_b32 v177, 0
  v_mov_b32 v178, 0
  v_mov_b32 v179, 0
  v_mov_b32 v180, 0
  v_mov_b32 v181, 0
  v_mov_b32 v182, 0
  v_mov_b32 v183, 0
  v_mov_b32 v184, 0
  v_mov_b32 v185, 0
  v_mov_b32 v186, 0
  v_mov_b32 v187, 0
  v_mov_b32 v188, 0
  v_mov_b32 v189, 0
  v_mov_b32 v190, 0
  v_mov_b32 v191, 0
  v_cmp_gt_u32 vcc, 28, v1
  s_and_saveexec_b64 s[18:19], vcc
  ds_write_b128 v200, v[160:163] offset:4096
  ds_write_b128 v200, v[160:163] offset:8736
  s_mov_b64 exec, s[18:19]
  s_branch L_kgen
L_uphase:
  s_setprio 2
  s_waitcnt vmcnt(7)
  v_perm_b32 v44, v16, v17, s56
  v_perm_b32 v48, v16, v17, s57
  v_perm_b32 v45, v14, v15, s56
  v_perm_b32 v49, v14, v15, s57
  v_perm_b32 v46, v12, v13, s56
  v_perm_b32 v50, v12, v13, s57
  v_perm_b32 v47, v10, v11, s56
  v_perm_b32 v51, v10, v11, s57
  ds_write_b128 v4, v[44:47]
  ds_write_b128 v4, v[48:51] offset:80
  ds_read_b128 v[52:55], v5
  ds_read_b128 v[56:59], v5 offset:1280
  s_waitcnt lgkmcnt(1)
  global_store_dwordx4 v6, v[52:55], s[52:53] sc1
  s_waitcnt lgkmcnt(0)
  global_store_dwordx4 v7, v[56:59], s[52:53] sc1
  global_load_dwordx4 v[124:127], v243, s[16:17]
  global_load_dwordx4 v[128:131], v243, s[16:17] offset:1024
  global_load_dwordx4 v[132:135], v241, s[46:47]
  global_load_dwordx4 v[244:247], v242, s[42:43]
  global_load_dwordx4 v[248:251], v242, s[42:43] offset:1024
  s_setprio 0
L_kgen:
  v_mov_b32 v220, 0
  v_mov_b32 v221, 0
  v_mov_b32 v222, 0
  v_mov_b32 v223, 0
  v_mov_b32 v224, 0
  v_mov_b32 v225, 0
  v_mov_b32 v226, 0
  v_mov_b32 v227, 0
  v_mov_b32 v228, 0
  v_mov_b32 v229, 0
  v_mov_b32 v230, 0
  v_mov_b32 v231, 0
  v_lshrrev_b32 v42, 3, v2
  v_and_b32 v43, 7, v2
  v_lshl_add_u32 v42, v42, 7, v43
  v_cvt_f32_u32 v208, v42
  v_lshrrev_b32 v42, 2, v2
  v_and_b32 v43, 3, v2
  v_lshlrev_b32 v43, 1, v43
  v_lshl_add_u32 v42, v42, 7, v43
  v_add_u32 v42, 256, v42
  v_lshrrev_b32 v44, 1, v2
  v_and_b32 v43, 1, v2
  v_lshlrev_b32 v43, 2, v43
  v_cmp_gt_u32 vcc, 8, v2
  v_lshl_add_u32 v44, v44, 7, v43
  v_lshlrev_b32 v45, 7, v2
  v_cndmask_b32 v42, v44, v42, vcc
  v_cvt_f32_u32 v209, v42
  v_add_u32 v45, 1024, v45
  v_cvt_f32_u32 v210, v45
  v_lshlrev_b32 v42, 3, v2
  v_cvt_f32_u32 v211, v42
  s_mul_i32 s12, s3, 3072
  v_mov_b32 v46, s12
  v_lshrrev_b32 v42, 1, v3
  v_and_b32 v43, 1, v3
  v_lshlrev_b32 v43, 2, v43
  v_lshl_add_u32 v42, v42, 7, v43
  v_lshl_add_u32 v42, v2, 3, v42
  v_lshl_add_u32 v204, v42, 2, v46
  v_lshlrev_b32 v42, 6, v3
  v_add_u32 v42, 256, v42
  v_lshl_add_u32 v43, v2, 2, v42
  v_lshl_add_u32 v44, v2, 1, v42
  v_cmp_gt_u32 vcc, 2, v3
  v_add_u32 v45, 2, v43
  v_add_u32 v47, 32, v44
  v_cndmask_b32 v43, v44, v43, vcc
  v_cndmask_b32 v45, v47, v45, vcc
  v_lshl_add_u32 v205, v43, 2, v46
  v_lshl_add_u32 v206, v45, 2, v46
  v_lshlrev_b32 v42, 6, v3
  v_add3_u32 v42, v42, v2, 0
  v_add_u32 v42, 512, v42
  v_lshl_add_u32 v207, v42, 2, v46
  s_lshl_b32 s12, s3, 9
  s_add_u32 s12, s12, 24704
  v_and_b32 v42, 31, v1
  v_lshlrev_b32 v42, 4, v42
  v_add_u32 v216, s12, v42
  v_lshlrev_b32 v42, 6, v3
  v_add_u32 v217, s12, v42
  v_lshrrev_b32 v41, 8, v0
  v_and_b32 v40, 255, v0
  v_mul_u32_u24 v42, 12288, v41
  v_lshlrev_b32 v43, 3, v40
  v_cmp_gt_u32 vcc, 16, v40
  v_add_u32 v44, 0, v43
  v_add_u32 v45, 1, v43
  v_cvt_f32_u32 v46, v44
  v_cvt_f32_u32 v47, v45
  v_cvt_pk_bf16_f32 v46, v46, v47
  v_and_b32 v47, s54, v46
  v_lshrrev_b32 v46, 16, v46
  v_subrev_u32 v47, 17024, v47
  v_subrev_u32 v46, 17024, v46
  v_cndmask_b32 v47, v47, v44, vcc
  v_cndmask_b32 v46, v46, v45, vcc
  v_lshl_add_u32 v116, v47, 2, v42
  v_lshl_add_u32 v117, v46, 2, v42
  v_add_u32 v44, 2, v43
  v_add_u32 v45, 3, v43
  v_cvt_f32_u32 v46, v44
  v_cvt_f32_u32 v47, v45
  v_cvt_pk_bf16_f32 v46, v46, v47
  v_and_b32 v47, s54, v46
  v_lshrrev_b32 v46, 16, v46
  v_subrev_u32 v47, 17024, v47
  v_subrev_u32 v46, 17024, v46
  v_cndmask_b32 v47, v47, v44, vcc
  v_cndmask_b32 v46, v46, v45, vcc
  v_lshl_add_u32 v118, v47, 2, v42
  v_lshl_add_u32 v119, v46, 2, v42
  v_add_u32 v44, 4, v43
  v_add_u32 v45, 5, v43
  v_cvt_f32_u32 v46, v44
  v_cvt_f32_u32 v47, v45
  v_cvt_pk_bf16_f32 v46, v46, v47
  v_and_b32 v47, s54, v46
  v_lshrrev_b32 v46, 16, v46
  v_subrev_u32 v47, 17024, v47
  v_subrev_u32 v46, 17024, v46
  v_cndmask_b32 v47, v47, v44, vcc
  v_cndmask_b32 v46, v46, v45, vcc
  v_lshl_add_u32 v120, v47, 2, v42
  v_lshl_add_u32 v121, v46, 2, v42
  v_add_u32 v44, 6, v43
  v_add_u32 v45, 7, v43
  v_cvt_f32_u32 v46, v44
  v_cvt_f32_u32 v47, v45
  v_cvt_pk_bf16_f32 v46, v46, v47
  v_and_b32 v47, s54, v46
  v_lshrrev_b32 v46, 16, v46
  v_subrev_u32 v47, 17024, v47
  v_subrev_u32 v46, 17024, v46
  v_cndmask_b32 v47, v47, v44, vcc
  v_cndmask_b32 v46, v46, v45, vcc
  v_lshl_add_u32 v122, v47, 2, v42
  v_lshl_add_u32 v123, v46, 2, v42
  v_mul_u32_u24 v44, 8448, v41
  v_lshl_add_u32 v44, v40, 4, v44
  v_add_u32 v219, 90304, v44
  s_waitcnt vmcnt(7)
  s_cmp_ge_u32 s3, 4
  s_cbranch_scc1 L_kp
  s_waitcnt vmcnt(2)
L_kp:
  v_lshlrev_b32 v232, 16, v232
  v_lshlrev_b32 v233, 16, v233
  v_lshlrev_b32 v234, 16, v234
  v_lshlrev_b32 v235, 16, v235
  v_lshlrev_b32 v236, 16, v236
  v_lshlrev_b32 v237, 16, v237
  v_lshlrev_b32 v238, 16, v238
  v_mul_f32 v42, 0x3fb8aa00, v238
  v_mul_f32 v43, 0x36a407db, v238
  v_exp_f32 v42, v42
  s_nop 0
  v_fma_f32 v42, v42, v43, v42
  v_cvt_pk_bf16_f32 v42, v42, v42
  v_lshlrev_b32 v44, 16, v42
  v_mul_f32 v42, 0x3fb8aa3b, v44
  v_mul_f32 v43, 0x3e22f983, v44
  v_pk_mul_f32 v[232:233], v[232:233], v[42:43]
  v_pk_mul_f32 v[46:47], v[234:235], v[44:45] op_sel:[0,0] op_sel_hi:[1,0]
  v_pk_mul_f32 v[48:49], v[236:237], v[46:47] op_sel:[0,0] op_sel_hi:[0,1]
  v_pk_fma_f32 v[234:235], v[236:237], v[46:47], v[48:49] op_sel:[1,1,0] op_sel_hi:[1,0,1] neg_lo:[1,0,0]
  v_max_f32 v50, |v234|, |v235|
  s_nop 1
  v_max_f32_dpp v50, v50, v50 row_shr:1 row_mask:0xf bank_mask:0xf bound_ctrl:0
  s_nop 1
  v_max_f32_dpp v50, v50, v50 row_shr:2 row_mask:0xf bank_mask:0xf bound_ctrl:0
  s_nop 1
  v_max_f32_dpp v50, v50, v50 row_shr:4 row_mask:0xf bank_mask:0xf bound_ctrl:0
  s_nop 1
  v_max_f32_dpp v50, v50, v50 row_shr:8 row_mask:0xf bank_mask:0xf bound_ctrl:0
  s_nop 1
  v_max_f32_dpp v50, v50, v50 row_bcast:15 row_mask:0xa bank_mask:0xf
  s_nop 1
  v_readlane_b32 s12, v50, 31
  s_nop 1
  v_mov_b32 v50, s12
  v_frexp_exp_i32_f32 v50, v50
  v_sub_u32 v51, 0, v50
  v_ldexp_f32 v218, 1.0, v50
  v_ldexp_f32 v234, v234, v51
  v_ldexp_f32 v235, v235, v51
  ds_write_b128 v216, v[232:235]
  s_mov_b32 s59, 0
  s_mov_b32 s34, 0
  v_mov_b32 v48, 24576
  v_mov_b32 v49, 1
  s_lshr_b32 s8, s4, 1
  s_lshl_b32 s8, s8, 6
  s_and_b32 s9, s4, 1
  s_lshl_b32 s9, s9, 4
  s_add_u32 s8, s8, s9
  v_mov_b32 v50, s8
  s_waitcnt vmcnt(5)
  s_cmp_ge_u32 s3, 4
  s_cbranch_scc1 L_arr0
  s_waitcnt vmcnt(0)
L_arr0:
  s_mov_b64 exec, 1
  ds_add_rtn_u32 v52, v48, v49
  s_waitcnt lgkmcnt(0)
  v_cmp_eq_u32 vcc, 7, v52
  s_and_b64 exec, exec, vcc
  s_cbranch_execz L_arr1
  global_atomic_add v51, v50, v49, s[50:51] sc0 sc1
  s_mov_b32 s34, 1
L_arr1:
  s_mov_b64 exec, -1
L_kstart:
  ds_read_b128 v[40:43], v217
L_kloop:
  s_waitcnt lgkmcnt(0)
L_kb0:
  ds_read_b128 v[44:47], v217 offset:16
  v_pk_mul_f32 v[92:93], v[40:41], v[208:209] op_sel:[0,0] op_sel_hi:[1,0]
  v_pk_mul_f32 v[94:95], v[40:41], v[208:209] op_sel:[0,1] op_sel_hi:[1,1]
  v_pk_mul_f32 v[96:97], v[40:41], v[210:211] op_sel:[0,0] op_sel_hi:[1,0]
  v_pk_mul_f32 v[98:99], v[40:41], v[210:211] op_sel:[0,1] op_sel_hi:[1,1]
  v_fract_f32 v24, v93
  v_fract_f32 v25, v95
  v_fract_f32 v26, v97
  v_fract_f32 v27, v99
  v_exp_f32 v16, v92
  v_cos_f32 v8, v24
  v_sin_f32 v9, v24
  v_exp_f32 v18, v94
  v_cos_f32 v10, v25
  v_sin_f32 v11, v25
  v_exp_f32 v20, v96
  v_cos_f32 v12, v26
  v_sin_f32 v13, v26
  v_exp_f32 v22, v98
  v_cos_f32 v14, v27
  v_sin_f32 v15, v27
  s_nop 0
  v_pk_mul_f32 v[76:77], v[8:9], v[16:17] op_sel:[0,0] op_sel_hi:[1,0]
  v_pk_mul_f32 v[78:79], v[10:11], v[18:19] op_sel:[0,0] op_sel_hi:[1,0]
  v_pk_mul_f32 v[80:81], v[12:13], v[20:21] op_sel:[0,0] op_sel_hi:[1,0]
  v_pk_mul_f32 v[82:83], v[14:15], v[22:23] op_sel:[0,0] op_sel_hi:[1,0]
  v_pk_mul_f32 v[30:31], v[82:83], v[42:43] op_sel:[0,0] op_sel_hi:[0,1]
  v_cvt_pk_f16_f32 v100, v76, v77
  v_cvt_pk_f16_f32 v104, v78, v79
  v_cvt_pk_f16_f32 v108, v80, v81
  v_pk_fma_f32 v[30:31], v[82:83], v[42:43], v[30:31] op_sel:[1,1,0] op_sel_hi:[1,0,1] neg_lo:[1,0,0] neg_hi:[1,0,1]
  v_cvt_pk_f16_f32 v112, v30, v31
  s_waitcnt lgkmcnt(0)
  ds_read_b128 v[40:43], v217 offset:32
  v_pk_mul_f32 v[92:93], v[44:45], v[208:209] op_sel:[0,0] op_sel_hi:[1,0]
  v_pk_mul_f32 v[94:95], v[44:45], v[208:209] op_sel:[0,1] op_sel_hi:[1,1]
  v_pk_mul_f32 v[96:97], v[44:45], v[210:211] op_sel:[0,0] op_sel_hi:[1,0]
  v_pk_mul_f32 v[98:99], v[44:45], v[210:211] op_sel:[0,1] op_sel_hi:[1,1]
  v_fract_f32 v24, v93
  v_fract_f32 v25, v95
  v_fract_f32 v26, v97
  v_fract_f32 v27, v99
  v_exp_f32 v16, v92
  v_cos_f32 v8, v24
  v_sin_f32 v9, v24
  v_exp_f32 v18, v94
  v_cos_f32 v10, v25
  v_sin_f32 v11, v25
  v_exp_f32 v20, v96
  v_cos_f32 v12, v26
  v_sin_f32 v13, v26
  v_exp_f32 v22, v98
  v_cos_f32 v14, v27
  v_sin_f32 v15, v27
  s_nop 0
  v_pk_mul_f32 v[76:77], v[8:9], v[16:17] op_sel:[0,0] op_sel_hi:[1,0]
  v_pk_mul_f32 v[78:79], v[10:11], v[18:19] op_sel:[0,0] op_sel_hi:[1,0]
  v_pk_mul_f32 v[80:81], v[12:13], v[20:21] op_sel:[0,0] op_sel_hi:[1,0]
  v_pk_mul_f32 v[82:83], v[14:15], v[22:23] op_sel:[0,0] op_sel_hi:[1,0]
  v_pk_mul_f32 v[30:31], v[82:83], v[46:47] op_sel:[0,0] op_sel_hi:[0,1]
  v_cvt_pk_f16_f32 v101, v76, v77
  v_cvt_pk_f16_f32 v105, v78, v79
  v_cvt_pk_f16_f32 v109, v80, v81
  v_pk_fma_f32 v[30:31], v[82:83], v[46:47], v[30:31] op_sel:[1,1,0] op_sel_hi:[1,0,1] neg_lo:[1,0,0] neg_hi:[1,0,1]
  v_cvt_pk_f16_f32 v113, v30, v31
  s_cbranch_execz L_warm_ret
  s_cmp_eq_u32 s34, 0
  s_cbranch_scc1 L_skip_arr2
  s_mov_b32 s34, 0
  s_waitcnt vmcnt(0)
  s_mov_b64 exec, 1
  v_and_b32 v51, 31, v51
  v_cmp_eq_u32 vcc, 31, v51
  s_and_b64 exec, exec, vcc
  s_cbranch_execz L_arr_done
  s_mov_b64 exec, 0xffffffff
  v_lshlrev_b32 v52, 10, v1
  s_lshl_b32 s8, s4, 7
  s_add_u32 s8, s8, 0x700000
  v_add_u32 v52, s8, v52
  global_atomic_add v52, v49, s[52:53] sc1
L_arr_done:
  s_mov_b64 exec, -1
L_skip_arr2:
  s_waitcnt lgkmcnt(0)
L_kb2:
  ds_read_b128 v[44:47], v217 offset:48
  v_pk_mul_f32 v[92:93], v[40:41], v[208:209] op_sel:[0,0] op_sel_hi:[1,0]
  v_pk_mul_f32 v[94:95], v[40:41], v[208:209] op_sel:[0,1] op_sel_hi:[1,1]
  v_pk_mul_f32 v[96:97], v[40:41], v[210:211] op_sel:[0,0] op_sel_hi:[1,0]
  v_pk_mul_f32 v[98:99], v[40:41], v[210:211] op_sel:[0,1] op_sel_hi:[1,1]
  v_fract_f32 v24, v93
  v_fract_f32 v25, v95
  v_fract_f32 v26, v97
  v_fract_f32 v27, v99
  v_exp_f32 v16, v92
  v_cos_f32 v8, v24
  v_sin_f32 v9, v24
  v_exp_f32 v18, v94
  v_cos_f32 v10, v25
  v_sin_f32 v11, v25
  v_exp_f32 v20, v96
  v_cos_f32 v12, v26
  v_sin_f32 v13, v26
  v_exp_f32 v22, v98
  v_cos_f32 v14, v27
  v_sin_f32 v15, v27
  s_nop 0
  v_pk_mul_f32 v[76:77], v[8:9], v[16:17] op_sel:[0,0] op_sel_hi:[1,0]
  v_pk_mul_f32 v[78:79], v[10:11], v[18:19] op_sel:[0,0] op_sel_hi:[1,0]
  v_pk_mul_f32 v[80:81], v[12:13], v[20:21] op_sel:[0,0] op_sel_hi:[1,0]
  v_pk_mul_f32 v[82:83], v[14:15], v[22:23] op_sel:[0,0] op_sel_hi:[1,0]
  v_pk_mul_f32 v[30:31], v[82:83], v[42:43] op_sel:[0,0] op_sel_hi:[0,1]
  v_cvt_pk_f16_f32 v102, v76, v77
  v_cvt_pk_f16_f32 v106, v78, v79
  v_cvt_pk_f16_f32 v110, v80, v81
  v_pk_fma_f32 v[30:31], v[82:83], v[42:43], v[30:31] op_sel:[1,1,0] op_sel_hi:[1,0,1] neg_lo:[1,0,0] neg_hi:[1,0,1]
  v_cvt_pk_f16_f32 v114, v30, v31
  s_waitcnt lgkmcnt(0)
  ds_read_b128 v[40:43], v217 offset:256
  v_pk_mul_f32 v[92:93], v[44:45], v[208:209] op_sel:[0,0] op_sel_hi:[1,0]
  v_pk_mul_f32 v[94:95], v[44:45], v[208:209] op_sel:[0,1] op_sel_hi:[1,1]
  v_pk_mul_f32 v[96:97], v[44:45], v[210:211] op_sel:[0,0] op_sel_hi:[1,0]
  v_pk_mul_f32 v[98:99], v[44:45], v[210:211] op_sel:[0,1] op_sel_hi:[1,1]
  v_fract_f32 v24, v93
  v_fract_f32 v25, v95
  v_fract_f32 v26, v97
  v_fract_f32 v27, v99
  v_exp_f32 v16, v92
  v_cos_f32 v8, v24
  v_sin_f32 v9, v24
  v_exp_f32 v18, v94
  v_cos_f32 v10, v25
  v_sin_f32 v11, v25
  v_exp_f32 v20, v96
  v_cos_f32 v12, v26
  v_sin_f32 v13, v26
  v_exp_f32 v22, v98
  v_cos_f32 v14, v27
  v_sin_f32 v15, v27
  s_nop 0
  v_pk_mul_f32 v[76:77], v[8:9], v[16:17] op_sel:[0,0] op_sel_hi:[1,0]
  v_pk_mul_f32 v[78:79], v[10:11], v[18:19] op_sel:[0,0] op_sel_hi:[1,0]
  v_pk_mul_f32 v[80:81], v[12:13], v[20:21] op_sel:[0,0] op_sel_hi:[1,0]
  v_pk_mul_f32 v[82:83], v[14:15], v[22:23] op_sel:[0,0] op_sel_hi:[1,0]
  v_pk_mul_f32 v[30:31], v[82:83], v[46:47] op_sel:[0,0] op_sel_hi:[0,1]
  v_cvt_pk_f16_f32 v103, v76, v77
  v_cvt_pk_f16_f32 v107, v78, v79
  v_cvt_pk_f16_f32 v111, v80, v81
  v_pk_fma_f32 v[30:31], v[82:83], v[46:47], v[30:31] op_sel:[1,1,0] op_sel_hi:[1,0,1] neg_lo:[1,0,0] neg_hi:[1,0,1]
  v_cvt_pk_f16_f32 v115, v30, v31
  s_cbranch_execz L_warm_ret
  v_add_u32 v217, 256, v217
  s_nop 0
  v_mfma_f32_16x16x32_f16 v[220:223], v[100:103], v[112:115], v[220:223]
  v_mfma_f32_16x16x32_f16 v[224:227], v[104:107], v[112:115], v[224:227]
  v_mfma_f32_16x16x32_f16 v[228:231], v[108:111], v[112:115], v[228:231]
  s_cmp_lg_u32 s59, 0
  s_cbranch_scc1 L_kdone
  s_mov_b32 s59, 1
  s_branch L_kloop
L_kdone:
  v_mul_f32 v220, v218, v220
  v_mul_f32 v221, v218, v221
  v_mul_f32 v222, v218, v222
  v_mul_f32 v223, v218, v223
  v_mul_f32 v224, v218, v224
  v_mul_f32 v225, v218, v225
  v_mul_f32 v226, v218, v226
  v_mul_f32 v227, v218, v227
  v_mul_f32 v228, v218, v228
  v_mul_f32 v229, v218, v229
  v_mul_f32 v230, v218, v230
  v_mul_f32 v231, v218, v231
  ds_write_b128 v204, v[220:223]
  ds_write_b64 v205, v[224:225]
  ds_write_b64 v206, v[226:227]
  ds_write_b32 v207, v228 offset:0
  ds_write_b32 v207, v229 offset:64
  ds_write_b32 v207, v230 offset:128
  ds_write_b32 v207, v231 offset:192
  s_cmp_lt_u32 s3, 4
  s_cbranch_scc1 L_nossm
  s_waitcnt vmcnt(0)
  ds_write_b128 v240, v[244:247]
  ds_write_b128 v240, v[248:251] offset:1024
L_nossm:
  s_waitcnt lgkmcnt(0)
  s_barrier
  ds_read2st64_b32 v[48:49], v116 offset0:0 offset1:12
  ds_read2st64_b32 v[50:51], v116 offset0:24 offset1:36
  ds_read2st64_b32 v[52:53], v117 offset0:0 offset1:12
  ds_read2st64_b32 v[54:55], v117 offset0:24 offset1:36
  ds_read2st64_b32 v[56:57], v118 offset0:0 offset1:12
  ds_read2st64_b32 v[58:59], v118 offset0:24 offset1:36
  ds_read2st64_b32 v[60:61], v119 offset0:0 offset1:12
  ds_read2st64_b32 v[62:63], v119 offset0:24 offset1:36
  ds_read2st64_b32 v[64:65], v120 offset0:0 offset1:12
  ds_read2st64_b32 v[66:67], v120 offset0:24 offset1:36
  ds_read2st64_b32 v[68:69], v121 offset0:0 offset1:12
  ds_read2st64_b32 v[70:71], v121 offset0:24 offset1:36
  ds_read2st64_b32 v[72:73], v122 offset0:0 offset1:12
  ds_read2st64_b32 v[74:75], v122 offset0:24 offset1:36
  ds_read2st64_b32 v[76:77], v123 offset0:0 offset1:12
  ds_read2st64_b32 v[78:79], v123 offset0:24 offset1:36
  s_lshl_b32 s8, s6, 1
  v_mov_b32 v7, s8
  global_load_dword v252, v7, s[32:33]
  global_load_dword v253, v7, s[44:45]
  s_waitcnt lgkmcnt(12)
  v_pk_add_f32 v[48:49], v[48:49], v[50:51]
  v_pk_add_f32 v[52:53], v[52:53], v[54:55]
  v_add_f32 v48, v48, v49
  v_add_f32 v52, v52, v53
  v_cvt_pk_bf16_f32 v84, v48, v52
  s_waitcnt lgkmcnt(8)
  v_pk_add_f32 v[56:57], v[56:57], v[58:59]
  v_pk_add_f32 v[60:61], v[60:61], v[62:63]
  v_add_f32 v56, v56, v57
  v_add_f32 v60, v60, v61
  v_cvt_pk_bf16_f32 v85, v56, v60
  s_waitcnt lgkmcnt(4)
  v_pk_add_f32 v[64:65], v[64:65], v[66:67]
  v_pk_add_f32 v[68:69], v[68:69], v[70:71]
  v_add_f32 v64, v64, v65
  v_add_f32 v68, v68, v69
  v_cvt_pk_bf16_f32 v86, v64, v68
  s_waitcnt lgkmcnt(0)
  v_pk_add_f32 v[72:73], v[72:73], v[74:75]
  v_pk_add_f32 v[76:77], v[76:77], v[78:79]
  v_add_f32 v72, v72, v73
  v_add_f32 v76, v76, v77
  v_cvt_pk_bf16_f32 v87, v72, v76
  ds_write_b128 v219, v[84:87]
  s_cmp_ge_u32 s3, 4
  s_cbranch_scc1 L_upost
  s_mov_b32 s58, 0
  s_mov_b64 exec, 1
  global_load_dword v9, v242, s[52:53] sc1
  s_sleep 1
  global_load_dword v14, v242, s[52:53] sc1
  s_sleep 1
  global_load_dword v15, v242, s[52:53] sc1
  s_sleep 1
L_pollT:
  global_load_dword v16, v242, s[52:53] sc1
  s_waitcnt vmcnt(3)
  v_cmp_ne_u32 vcc, v240, v9
  s_add_u32 s58, s58, 1
  s_nop 0
  s_cbranch_vccz L_pollT_done
  s_sleep 1
  global_load_dword v9, v242, s[52:53] sc1
  s_waitcnt vmcnt(3)
  v_cmp_ne_u32 vcc, v240, v14
  s_add_u32 s58, s58, 1
  s_nop 0
  s_cbranch_vccz L_pollT_done
  s_sleep 1
  global_load_dword v14, v242, s[52:53] sc1
  s_waitcnt vmcnt(3)
  v_cmp_ne_u32 vcc, v240, v15
  s_add_u32 s58, s58, 1
  s_nop 0
  s_cbranch_vccz L_pollT_done
  s_sleep 1
  global_load_dword v15, v242, s[52:53] sc1
  s_waitcnt vmcnt(3)
  v_cmp_ne_u32 vcc, v240, v16
  s_add_u32 s58, s58, 1
  s_nop 0
  s_cbranch_vccz L_pollT_done
  s_sleep 1
  s_cmp_lt_u32 s58, 262144
  s_cbranch_scc1 L_pollT
L_pollT_done:
  s_waitcnt vmcnt(0)
  s_mov_b64 exec, -1
  buffer_load_dwordx4 v[8:11], v202, s[36:39], 0 offen offset:0 sc1
  buffer_load_dwordx4 v[12:15], v202, s[36:39], 0 offen offset:1024 sc1
  buffer_load_dwordx4 v[16:19], v202, s[36:39], 0 offen offset:2048 sc1
  buffer_load_dwordx4 v[20:23], v202, s[36:39], 0 offen offset:3072 sc1
  buffer_load_dword v24, v203, s[36:39], 0 offen offset:0 sc1
  buffer_load_dword v25, v203, s[36:39], 0 offen offset:1024 sc1
  buffer_load_dword v26, v203, s[36:39], 0 offen offset:2048 sc1
  buffer_load_dword v27, v203, s[36:39], 0 offen offset:3072 sc1
  s_waitcnt lgkmcnt(0)
  s_barrier
  ds_read2_b32 v[32:33], v192 offset0:0 offset1:1
  ds_read2_b32 v[34:35], v192 offset0:2 offset1:3
  ds_read2_b32 v[36:37], v193 offset0:0 offset1:1
  ds_read2_b32 v[38:39], v193 offset0:2 offset1:3
  ds_read2_b32 v[40:41], v194 offset0:0 offset1:1
  ds_read2_b32 v[42:43], v194 offset0:2 offset1:3
  ds_read2_b32 v[44:45], v195 offset0:0 offset1:1
  ds_read2_b32 v[46:47], v195 offset0:2 offset1:3
  ds_read2_b32 v[48:49], v196 offset0:0 offset1:1
  ds_read2_b32 v[50:51], v196 offset0:2 offset1:3
  ds_read2_b32 v[52:53], v197 offset0:0 offset1:1
  ds_read2_b32 v[54:55], v197 offset0:2 offset1:3
  ds_read2_b32 v[56:57], v198 offset0:0 offset1:1
  ds_read2_b32 v[58:59], v198 offset0:2 offset1:3
  ds_read2_b32 v[60:61], v199 offset0:0 offset1:1
  ds_read2_b32 v[62:63], v199 offset0:2 offset1:3
  s_waitcnt vmcnt(3)
  ds_write_b128 v200, v[8:11] offset:0
  v_alignbit_b32 v28, v9, v8, 16
  v_alignbit_b32 v29, v10, v9, 16
  v_alignbit_b32 v30, v11, v10, 16
  v_alignbit_b32 v31, v24, v11, 16
  ds_write_b128 v200, v[28:31] offset:4640
  s_nop 1
  s_waitcnt vmcnt(2)
  ds_write_b128 v200, v[12:15] offset:1024
  v_alignbit_b32 v28, v13, v12, 16
  v_alignbit_b32 v29, v14, v13, 16
  v_alignbit_b32 v30, v15, v14, 16
  v_alignbit_b32 v31, v25, v15, 16
  ds_write_b128 v200, v[28:31] offset:5664
  s_nop 1
  s_waitcnt vmcnt(1)
  ds_write_b128 v200, v[16:19] offset:2048
  v_alignbit_b32 v28, v17, v16, 16
  v_alignbit_b32 v29, v18, v17, 16
  v_alignbit_b32 v30, v19, v18, 16
  v_alignbit_b32 v31, v26, v19, 16
  ds_write_b128 v200, v[28:31] offset:6688
  s_nop 1
  s_waitcnt vmcnt(0)
  ds_write_b128 v200, v[20:23] offset:3072
  v_alignbit_b32 v28, v21, v20, 16
  v_alignbit_b32 v29, v22, v21, 16
  v_alignbit_b32 v30, v23, v22, 16
  v_alignbit_b32 v31, v27, v23, 16
  ds_write_b128 v200, v[28:31] offset:7712
  s_nop 1
  ds_read_b128 v[64:67], v201 offset:3584
  ds_read_b128 v[68:71], v201 offset:3072
  ds_read_b128 v[72:75], v201 offset:2560
  ds_read_b128 v[76:79], v201 offset:2048
  ds_read_b128 v[80:83], v201 offset:1536
  ds_read_b128 v[84:87], v201 offset:1024
  ds_read_b128 v[88:91], v201 offset:512
  ds_read_b128 v[92:95], v201 offset:0
  s_lshl_b32 s8, s3, 12
  s_add_u32 s8, s8, 36992
  v_lshlrev_b32 v5, 7, v3
  v_lshl_add_u32 v5, v2, 2, v5
  v_add_u32 v5, s8, v5
  v_mov_b32 v6, 24580
  v_mov_b32 v7, 1
  s_waitcnt lgkmcnt(0)
  v_mfma_f32_16x16x32_bf16 v[160:163], v[64:67], v[32:35], v[160:163]
  ds_read2_b32 v[96:97], v192 offset0:16 offset1:17
  v_mfma_f32_16x16x32_bf16 v[164:167], v[68:71], v[32:35], v[164:167]
  ds_read2_b32 v[98:99], v192 offset0:18 offset1:19
  v_mfma_f32_16x16x32_bf16 v[168:171], v[72:75], v[32:35], v[168:171]
  ds_read_b128 v[128:131], v201 offset:3648
  v_mfma_f32_16x16x32_bf16 v[172:175], v[76:79], v[32:35], v[172:175]
  ds_read2_b32 v[100:101], v193 offset0:16 offset1:17
  v_mfma_f32_16x16x32_bf16 v[176:179], v[80:83], v[32:35], v[176:179]
  ds_read2_b32 v[102:103], v193 offset0:18 offset1:19
  v_mfma_f32_16x16x32_bf16 v[180:183], v[84:87], v[32:35], v[180:183]
  ds_read_b128 v[132:135], v201 offset:3136
  v_mfma_f32_16x16x32_bf16 v[184:187], v[88:91], v[32:35], v[184:187]
  ds_read2_b32 v[104:105], v194 offset0:16 offset1:17
  v_mfma_f32_16x16x32_bf16 v[188:191], v[92:95], v[32:35], v[188:191]
  ds_read2_b32 v[106:107], v194 offset0:18 offset1:19
  v_mfma_f32_16x16x32_bf16 v[164:167], v[64:67], v[36:39], v[164:167]
  ds_read_b128 v[136:139], v201 offset:2624
  v_mfma_f32_16x16x32_bf16 v[168:171], v[68:71], v[36:39], v[168:171]
  ds_read2_b32 v[108:109], v195 offset0:16 offset1:17
  v_mfma_f32_16x16x32_bf16 v[172:175], v[72:75], v[36:39], v[172:175]
  ds_read2_b32 v[110:111], v195 offset0:18 offset1:19
  v_mfma_f32_16x16x32_bf16 v[176:179], v[76:79], v[36:39], v[176:179]
  ds_read_b128 v[140:143], v201 offset:2112
  v_mfma_f32_16x16x32_bf16 v[180:183], v[80:83], v[36:39], v[180:183]
  ds_read2_b32 v[112:113], v196 offset0:16 offset1:17
  v_mfma_f32_16x16x32_bf16 v[184:187], v[84:87], v[36:39], v[184:187]
  ds_read2_b32 v[114:115], v196 offset0:18 offset1:19
  v_mfma_f32_16x16x32_bf16 v[188:191], v[88:91], v[36:39], v[188:191]
  ds_read_b128 v[144:147], v201 offset:1600
  v_mfma_f32_16x16x32_bf16 v[168:171], v[64:67], v[40:43], v[168:171]
  ds_read2_b32 v[116:117], v197 offset0:16 offset1:17
  v_mfma_f32_16x16x32_bf16 v[172:175], v[68:71], v[40:43], v[172:175]
  ds_read2_b32 v[118:119], v197 offset0:18 offset1:19
  v_mfma_f32_16x16x32_bf16 v[176:179], v[72:75], v[40:43], v[176:179]
  ds_read_b128 v[148:151], v201 offset:1088
  v_mfma_f32_16x16x32_bf16 v[180:183], v[76:79], v[40:43], v[180:183]
  ds_read2_b32 v[120:121], v198 offset0:16 offset1:17
  v_mfma_f32_16x16x32_bf16 v[184:187], v[80:83], v[40:43], v[184:187]
  ds_read2_b32 v[122:123], v198 offset0:18 offset1:19
  v_mfma_f32_16x16x32_bf16 v[188:191], v[84:87], v[40:43], v[188:191]
  ds_read_b128 v[152:155], v201 offset:576
  v_mfma_f32_16x16x32_bf16 v[172:175], v[64:67], v[44:47], v[172:175]
  ds_read2_b32 v[124:125], v199 offset0:16 offset1:17
  v_mfma_f32_16x16x32_bf16 v[176:179], v[68:71], v[44:47], v[176:179]
  ds_read2_b32 v[126:127], v199 offset0:18 offset1:19
  v_mfma_f32_16x16x32_bf16 v[180:183], v[72:75], v[44:47], v[180:183]
  ds_read_b128 v[156:159], v201 offset:64
  v_mfma_f32_16x16x32_bf16 v[184:187], v[76:79], v[44:47], v[184:187]
  v_mfma_f32_16x16x32_bf16 v[188:191], v[80:83], v[44:47], v[188:191]
  v_mfma_f32_16x16x32_bf16 v[176:179], v[64:67], v[48:51], v[176:179]
  v_mfma_f32_16x16x32_bf16 v[180:183], v[68:71], v[48:51], v[180:183]
  v_mfma_f32_16x16x32_bf16 v[184:187], v[72:75], v[48:51], v[184:187]
  v_mfma_f32_16x16x32_bf16 v[188:191], v[76:79], v[48:51], v[188:191]
  v_mfma_f32_16x16x32_bf16 v[180:183], v[64:67], v[52:55], v[180:183]
  v_mfma_f32_16x16x32_bf16 v[184:187], v[68:71], v[52:55], v[184:187]
  v_mfma_f32_16x16x32_bf16 v[188:191], v[72:75], v[52:55], v[188:191]
  v_mfma_f32_16x16x32_bf16 v[184:187], v[64:67], v[56:59], v[184:187]
  v_mfma_f32_16x16x32_bf16 v[188:191], v[68:71], v[56:59], v[188:191]
  v_mfma_f32_16x16x32_bf16 v[188:191], v[64:67], v[60:63], v[188:191]
  s_waitcnt lgkmcnt(0)
  v_mfma_f32_16x16x32_bf16 v[160:163], v[128:131], v[96:99], v[160:163]
  ds_read2_b32 v[32:33], v192 offset0:32 offset1:33
  v_mfma_f32_16x16x32_bf16 v[164:167], v[132:135], v[96:99], v[164:167]
  ds_read2_b32 v[34:35], v192 offset0:34 offset1:35
  v_mfma_f32_16x16x32_bf16 v[168:171], v[136:139], v[96:99], v[168:171]
  ds_read_b128 v[64:67], v201 offset:3712
  v_mfma_f32_16x16x32_bf16 v[172:175], v[140:143], v[96:99], v[172:175]
  ds_read2_b32 v[36:37], v193 offset0:32 offset1:33
  v_mfma_f32_16x16x32_bf16 v[176:179], v[144:147], v[96:99], v[176:179]
  ds_read2_b32 v[38:39], v193 offset0:34 offset1:35
  v_mfma_f32_16x16x32_bf16 v[180:183], v[148:151], v[96:99], v[180:183]
  ds_read_b128 v[68:71], v201 offset:3200
  v_mfma_f32_16x16x32_bf16 v[184:187], v[152:155], v[96:99], v[184:187]
  ds_read2_b32 v[40:41], v194 offset0:32 offset1:33
  v_mfma_f32_16x16x32_bf16 v[188:191], v[156:159], v[96:99], v[188:191]
  ds_read2_b32 v[42:43], v194 offset0:34 offset1:35
  v_mfma_f32_16x16x32_bf16 v[164:167], v[128:131], v[100:103], v[164:167]
  ds_read_b128 v[72:75], v201 offset:2688
  v_mfma_f32_16x16x32_bf16 v[168:171], v[132:135], v[100:103], v[168:171]
  ds_read2_b32 v[44:45], v195 offset0:32 offset1:33
  v_mfma_f32_16x16x32_bf16 v[172:175], v[136:139], v[100:103], v[172:175]
  ds_read2_b32 v[46:47], v195 offset0:34 offset1:35
  v_mfma_f32_16x16x32_bf16 v[176:179], v[140:143], v[100:103], v[176:179]
  ds_read_b128 v[76:79], v201 offset:2176
  v_mfma_f32_16x16x32_bf16 v[180:183], v[144:147], v[100:103], v[180:183]
  ds_read2_b32 v[48:49], v196 offset0:32 offset1:33
  v_mfma_f32_16x16x32_bf16 v[184:187], v[148:151], v[100:103], v[184:187]
  ds_read2_b32 v[50:51], v196 offset0:34 offset1:35
  v_mfma_f32_16x16x32_bf16 v[188:191], v[152:155], v[100:103], v[188:191]
  ds_read_b128 v[80:83], v201 offset:1664
  v_mfma_f32_16x16x32_bf16 v[168:171], v[128:131], v[104:107], v[168:171]
  ds_read2_b32 v[52:53], v197 offset0:32 offset1:33
  v_mfma_f32_16x16x32_bf16 v[172:175], v[132:135], v[104:107], v[172:175]
  ds_read2_b32 v[54:55], v197 offset0:34 offset1:35
  v_mfma_f32_16x16x32_bf16 v[176:179], v[136:139], v[104:107], v[176:179]
  ds_read_b128 v[84:87], v201 offset:1152
  v_mfma_f32_16x16x32_bf16 v[180:183], v[140:143], v[104:107], v[180:183]
  ds_read2_b32 v[56:57], v198 offset0:32 offset1:33
  v_mfma_f32_16x16x32_bf16 v[184:187], v[144:147], v[104:107], v[184:187]
  ds_read2_b32 v[58:59], v198 offset0:34 offset1:35
  v_mfma_f32_16x16x32_bf16 v[188:191], v[148:151], v[104:107], v[188:191]
  ds_read_b128 v[88:91], v201 offset:640
  v_mfma_f32_16x16x32_bf16 v[172:175], v[128:131], v[108:111], v[172:175]
  ds_read2_b32 v[60:61], v199 offset0:32 offset1:33
  v_mfma_f32_16x16x32_bf16 v[176:179], v[132:135], v[108:111], v[176:179]
  ds_read2_b32 v[62:63], v199 offset0:34 offset1:35
  v_mfma_f32_16x16x32_bf16 v[180:183], v[136:139], v[108:111], v[180:183]
  ds_read_b128 v[92:95], v201 offset:128
  v_mfma_f32_16x16x32_bf16 v[184:187], v[140:143], v[108:111], v[184:187]
  v_mfma_f32_16x16x32_bf16 v[188:191], v[144:147], v[108:111], v[188:191]
  v_mfma_f32_16x16x32_bf16 v[176:179], v[128:131], v[112:115], v[176:179]
  v_mfma_f32_16x16x32_bf16 v[180:183], v[132:135], v[112:115], v[180:183]
  v_mfma_f32_16x16x32_bf16 v[184:187], v[136:139], v[112:115], v[184:187]
  v_mfma_f32_16x16x32_bf16 v[188:191], v[140:143], v[112:115], v[188:191]
  v_mfma_f32_16x16x32_bf16 v[180:183], v[128:131], v[116:119], v[180:183]
  v_mfma_f32_16x16x32_bf16 v[184:187], v[132:135], v[116:119], v[184:187]
  v_mfma_f32_16x16x32_bf16 v[188:191], v[136:139], v[116:119], v[188:191]
  v_mfma_f32_16x16x32_bf16 v[184:187], v[128:131], v[120:123], v[184:187]
  v_mfma_f32_16x16x32_bf16 v[188:191], v[132:135], v[120:123], v[188:191]
  v_mfma_f32_16x16x32_bf16 v[188:191], v[128:131], v[124:127], v[188:191]
  s_waitcnt lgkmcnt(0)
  v_mfma_f32_16x16x32_bf16 v[160:163], v[64:67], v[32:35], v[160:163]
  ds_read2_b32 v[96:97], v192 offset0:48 offset1:49
  v_mfma_f32_16x16x32_bf16 v[164:167], v[68:71], v[32:35], v[164:167]
  ds_read2_b32 v[98:99], v192 offset0:50 offset1:51
  v_mfma_f32_16x16x32_bf16 v[168:171], v[72:75], v[32:35], v[168:171]
  ds_read_b128 v[128:131], v201 offset:3776
  v_mfma_f32_16x16x32_bf16 v[172:175], v[76:79], v[32:35], v[172:175]
  ds_read2_b32 v[100:101], v193 offset0:48 offset1:49
  v_mfma_f32_16x16x32_bf16 v[176:179], v[80:83], v[32:35], v[176:179]
  ds_read2_b32 v[102:103], v193 offset0:50 offset1:51
  v_mfma_f32_16x16x32_bf16 v[180:183], v[84:87], v[32:35], v[180:183]
  ds_read_b128 v[132:135], v201 offset:3264
  v_mfma_f32_16x16x32_bf16 v[184:187], v[88:91], v[32:35], v[184:187]
  ds_read2_b32 v[104:105], v194 offset0:48 offset1:49
  v_mfma_f32_16x16x32_bf16 v[188:191], v[92:95], v[32:35], v[188:191]
  ds_read2_b32 v[106:107], v194 offset0:50 offset1:51
  v_mfma_f32_16x16x32_bf16 v[164:167], v[64:67], v[36:39], v[164:167]
  ds_read_b128 v[136:139], v201 offset:2752
  v_mfma_f32_16x16x32_bf16 v[168:171], v[68:71], v[36:39], v[168:171]
  ds_read2_b32 v[108:109], v195 offset0:48 offset1:49
  v_mfma_f32_16x16x32_bf16 v[172:175], v[72:75], v[36:39], v[172:175]
  ds_read2_b32 v[110:111], v195 offset0:50 offset1:51
  v_mfma_f32_16x16x32_bf16 v[176:179], v[76:79], v[36:39], v[176:179]
  ds_read_b128 v[140:143], v201 offset:2240
  v_mfma_f32_16x16x32_bf16 v[180:183], v[80:83], v[36:39], v[180:183]
  ds_read2_b32 v[112:113], v196 offset0:48 offset1:49
  v_mfma_f32_16x16x32_bf16 v[184:187], v[84:87], v[36:39], v[184:187]
  ds_read2_b32 v[114:115], v196 offset0:50 offset1:51
  v_mfma_f32_16x16x32_bf16 v[188:191], v[88:91], v[36:39], v[188:191]
  ds_read_b128 v[144:147], v201 offset:1728
  v_mfma_f32_16x16x32_bf16 v[168:171], v[64:67], v[40:43], v[168:171]
  ds_read2_b32 v[116:117], v197 offset0:48 offset1:49
  v_mfma_f32_16x16x32_bf16 v[172:175], v[68:71], v[40:43], v[172:175]
  ds_read2_b32 v[118:119], v197 offset0:50 offset1:51
  v_mfma_f32_16x16x32_bf16 v[176:179], v[72:75], v[40:43], v[176:179]
  ds_read_b128 v[148:151], v201 offset:1216
  v_mfma_f32_16x16x32_bf16 v[180:183], v[76:79], v[40:43], v[180:183]
  ds_read2_b32 v[120:121], v198 offset0:48 offset1:49
  v_mfma_f32_16x16x32_bf16 v[184:187], v[80:83], v[40:43], v[184:187]
  ds_read2_b32 v[122:123], v198 offset0:50 offset1:51
  v_mfma_f32_16x16x32_bf16 v[188:191], v[84:87], v[40:43], v[188:191]
  ds_read_b128 v[152:155], v201 offset:704
  v_mfma_f32_16x16x32_bf16 v[172:175], v[64:67], v[44:47], v[172:175]
  ds_read2_b32 v[124:125], v199 offset0:48 offset1:49
  v_mfma_f32_16x16x32_bf16 v[176:179], v[68:71], v[44:47], v[176:179]
  ds_read2_b32 v[126:127], v199 offset0:50 offset1:51
  v_mfma_f32_16x16x32_bf16 v[180:183], v[72:75], v[44:47], v[180:183]
  ds_read_b128 v[156:159], v201 offset:192
  v_mfma_f32_16x16x32_bf16 v[184:187], v[76:79], v[44:47], v[184:187]
  v_mfma_f32_16x16x32_bf16 v[188:191], v[80:83], v[44:47], v[188:191]
  v_mfma_f32_16x16x32_bf16 v[176:179], v[64:67], v[48:51], v[176:179]
  v_mfma_f32_16x16x32_bf16 v[180:183], v[68:71], v[48:51], v[180:183]
  v_mfma_f32_16x16x32_bf16 v[184:187], v[72:75], v[48:51], v[184:187]
  v_mfma_f32_16x16x32_bf16 v[188:191], v[76:79], v[48:51], v[188:191]
  v_mfma_f32_16x16x32_bf16 v[180:183], v[64:67], v[52:55], v[180:183]
  v_mfma_f32_16x16x32_bf16 v[184:187], v[68:71], v[52:55], v[184:187]
  v_mfma_f32_16x16x32_bf16 v[188:191], v[72:75], v[52:55], v[188:191]
  v_mfma_f32_16x16x32_bf16 v[184:187], v[64:67], v[56:59], v[184:187]
  v_mfma_f32_16x16x32_bf16 v[188:191], v[68:71], v[56:59], v[188:191]
  v_mfma_f32_16x16x32_bf16 v[188:191], v[64:67], v[60:63], v[188:191]
  s_waitcnt lgkmcnt(0)
  v_mfma_f32_16x16x32_bf16 v[160:163], v[128:131], v[96:99], v[160:163]
  ds_read2_b32 v[32:33], v192 offset0:64 offset1:65
  v_mfma_f32_16x16x32_bf16 v[164:167], v[132:135], v[96:99], v[164:167]
  ds_read2_b32 v[34:35], v192 offset0:66 offset1:67
  v_mfma_f32_16x16x32_bf16 v[168:171], v[136:139], v[96:99], v[168:171]
  ds_read_b128 v[64:67], v201 offset:3840
  v_mfma_f32_16x16x32_bf16 v[172:175], v[140:143], v[96:99], v[172:175]
  ds_read2_b32 v[36:37], v193 offset0:64 offset1:65
  v_mfma_f32_16x16x32_bf16 v[176:179], v[144:147], v[96:99], v[176:179]
  ds_read2_b32 v[38:39], v193 offset0:66 offset1:67
  v_mfma_f32_16x16x32_bf16 v[180:183], v[148:151], v[96:99], v[180:183]
  ds_read_b128 v[68:71], v201 offset:3328
  v_mfma_f32_16x16x32_bf16 v[184:187], v[152:155], v[96:99], v[184:187]
  ds_read2_b32 v[40:41], v194 offset0:64 offset1:65
  v_mfma_f32_16x16x32_bf16 v[188:191], v[156:159], v[96:99], v[188:191]
  ds_read2_b32 v[42:43], v194 offset0:66 offset1:67
  v_mfma_f32_16x16x32_bf16 v[164:167], v[128:131], v[100:103], v[164:167]
  ds_read_b128 v[72:75], v201 offset:2816
  v_mfma_f32_16x16x32_bf16 v[168:171], v[132:135], v[100:103], v[168:171]
  ds_read2_b32 v[44:45], v195 offset0:64 offset1:65
  v_mfma_f32_16x16x32_bf16 v[172:175], v[136:139], v[100:103], v[172:175]
  ds_read2_b32 v[46:47], v195 offset0:66 offset1:67
  v_mfma_f32_16x16x32_bf16 v[176:179], v[140:143], v[100:103], v[176:179]
  ds_read_b128 v[76:79], v201 offset:2304
  v_mfma_f32_16x16x32_bf16 v[180:183], v[144:147], v[100:103], v[180:183]
  ds_read2_b32 v[48:49], v196 offset0:64 offset1:65
  v_mfma_f32_16x16x32_bf16 v[184:187], v[148:151], v[100:103], v[184:187]
  ds_read2_b32 v[50:51], v196 offset0:66 offset1:67
  v_mfma_f32_16x16x32_bf16 v[188:191], v[152:155], v[100:103], v[188:191]
  ds_read_b128 v[80:83], v201 offset:1792
  v_mfma_f32_16x16x32_bf16 v[168:171], v[128:131], v[104:107], v[168:171]
  ds_read2_b32 v[52:53], v197 offset0:64 offset1:65
  v_mfma_f32_16x16x32_bf16 v[172:175], v[132:135], v[104:107], v[172:175]
  ds_read2_b32 v[54:55], v197 offset0:66 offset1:67
  v_mfma_f32_16x16x32_bf16 v[176:179], v[136:139], v[104:107], v[176:179]
  ds_read_b128 v[84:87], v201 offset:1280
  v_mfma_f32_16x16x32_bf16 v[180:183], v[140:143], v[104:107], v[180:183]
  ds_read2_b32 v[56:57], v198 offset0:64 offset1:65
  v_mfma_f32_16x16x32_bf16 v[184:187], v[144:147], v[104:107], v[184:187]
  ds_read2_b32 v[58:59], v198 offset0:66 offset1:67
  v_mfma_f32_16x16x32_bf16 v[188:191], v[148:151], v[104:107], v[188:191]
  ds_read_b128 v[88:91], v201 offset:768
  v_mfma_f32_16x16x32_bf16 v[172:175], v[128:131], v[108:111], v[172:175]
  ds_read2_b32 v[60:61], v199 offset0:64 offset1:65
  v_mfma_f32_16x16x32_bf16 v[176:179], v[132:135], v[108:111], v[176:179]
  ds_read2_b32 v[62:63], v199 offset0:66 offset1:67
  v_mfma_f32_16x16x32_bf16 v[180:183], v[136:139], v[108:111], v[180:183]
  ds_read_b128 v[92:95], v201 offset:256
  v_mfma_f32_16x16x32_bf16 v[184:187], v[140:143], v[108:111], v[184:187]
  v_mfma_f32_16x16x32_bf16 v[188:191], v[144:147], v[108:111], v[188:191]
  v_mfma_f32_16x16x32_bf16 v[176:179], v[128:131], v[112:115], v[176:179]
  v_mfma_f32_16x16x32_bf16 v[180:183], v[132:135], v[112:115], v[180:183]
  v_mfma_f32_16x16x32_bf16 v[184:187], v[136:139], v[112:115], v[184:187]
  v_mfma_f32_16x16x32_bf16 v[188:191], v[140:143], v[112:115], v[188:191]
  v_mfma_f32_16x16x32_bf16 v[180:183], v[128:131], v[116:119], v[180:183]
  v_mfma_f32_16x16x32_bf16 v[184:187], v[132:135], v[116:119], v[184:187]
  v_mfma_f32_16x16x32_bf16 v[188:191], v[136:139], v[116:119], v[188:191]
  v_mfma_f32_16x16x32_bf16 v[184:187], v[128:131], v[120:123], v[184:187]
  v_mfma_f32_16x16x32_bf16 v[188:191], v[132:135], v[120:123], v[188:191]
  v_mfma_f32_16x16x32_bf16 v[188:191], v[128:131], v[124:127], v[188:191]
  s_waitcnt lgkmcnt(0)
  v_mfma_f32_16x16x32_bf16 v[160:163], v[64:67], v[32:35], v[160:163]
  ds_read2_b32 v[96:97], v192 offset0:80 offset1:81
  v_mfma_f32_16x16x32_bf16 v[164:167], v[68:71], v[32:35], v[164:167]
  ds_read2_b32 v[98:99], v192 offset0:82 offset1:83
  v_mfma_f32_16x16x32_bf16 v[168:171], v[72:75], v[32:35], v[168:171]
  ds_read_b128 v[128:131], v201 offset:3904
  v_mfma_f32_16x16x32_bf16 v[172:175], v[76:79], v[32:35], v[172:175]
  ds_read2_b32 v[100:101], v193 offset0:80 offset1:81
  v_mfma_f32_16x16x32_bf16 v[176:179], v[80:83], v[32:35], v[176:179]
  ds_read2_b32 v[102:103], v193 offset0:82 offset1:83
  v_mfma_f32_16x16x32_bf16 v[180:183], v[84:87], v[32:35], v[180:183]
  ds_read_b128 v[132:135], v201 offset:3392
  v_mfma_f32_16x16x32_bf16 v[184:187], v[88:91], v[32:35], v[184:187]
  ds_read2_b32 v[104:105], v194 offset0:80 offset1:81
  v_mfma_f32_16x16x32_bf16 v[188:191], v[92:95], v[32:35], v[188:191]
  ds_read2_b32 v[106:107], v194 offset0:82 offset1:83
  v_mfma_f32_16x16x32_bf16 v[164:167], v[64:67], v[36:39], v[164:167]
  ds_read_b128 v[136:139], v201 offset:2880
  v_mfma_f32_16x16x32_bf16 v[168:171], v[68:71], v[36:39], v[168:171]
  ds_read2_b32 v[108:109], v195 offset0:80 offset1:81
  v_mfma_f32_16x16x32_bf16 v[172:175], v[72:75], v[36:39], v[172:175]
  ds_read2_b32 v[110:111], v195 offset0:82 offset1:83
  v_mfma_f32_16x16x32_bf16 v[176:179], v[76:79], v[36:39], v[176:179]
  ds_read_b128 v[140:143], v201 offset:2368
  v_mfma_f32_16x16x32_bf16 v[180:183], v[80:83], v[36:39], v[180:183]
  ds_read2_b32 v[112:113], v196 offset0:80 offset1:81
  v_mfma_f32_16x16x32_bf16 v[184:187], v[84:87], v[36:39], v[184:187]
  ds_read2_b32 v[114:115], v196 offset0:82 offset1:83
  v_mfma_f32_16x16x32_bf16 v[188:191], v[88:91], v[36:39], v[188:191]
  ds_read_b128 v[144:147], v201 offset:1856
  v_mfma_f32_16x16x32_bf16 v[168:171], v[64:67], v[40:43], v[168:171]
  ds_read2_b32 v[116:117], v197 offset0:80 offset1:81
  v_mfma_f32_16x16x32_bf16 v[172:175], v[68:71], v[40:43], v[172:175]
  ds_read2_b32 v[118:119], v197 offset0:82 offset1:83
  v_mfma_f32_16x16x32_bf16 v[176:179], v[72:75], v[40:43], v[176:179]
  ds_read_b128 v[148:151], v201 offset:1344
  v_mfma_f32_16x16x32_bf16 v[180:183], v[76:79], v[40:43], v[180:183]
  ds_read2_b32 v[120:121], v198 offset0:80 offset1:81
  v_mfma_f32_16x16x32_bf16 v[184:187], v[80:83], v[40:43], v[184:187]
  ds_read2_b32 v[122:123], v198 offset0:82 offset1:83
  v_mfma_f32_16x16x32_bf16 v[188:191], v[84:87], v[40:43], v[188:191]
  ds_read_b128 v[152:155], v201 offset:832
  v_mfma_f32_16x16x32_bf16 v[172:175], v[64:67], v[44:47], v[172:175]
  ds_read2_b32 v[124:125], v199 offset0:80 offset1:81
  v_mfma_f32_16x16x32_bf16 v[176:179], v[68:71], v[44:47], v[176:179]
  ds_read2_b32 v[126:127], v199 offset0:82 offset1:83
  v_mfma_f32_16x16x32_bf16 v[180:183], v[72:75], v[44:47], v[180:183]
  ds_read_b128 v[156:159], v201 offset:320
  v_mfma_f32_16x16x32_bf16 v[184:187], v[76:79], v[44:47], v[184:187]
  v_mfma_f32_16x16x32_bf16 v[188:191], v[80:83], v[44:47], v[188:191]
  v_mfma_f32_16x16x32_bf16 v[176:179], v[64:67], v[48:51], v[176:179]
  v_mfma_f32_16x16x32_bf16 v[180:183], v[68:71], v[48:51], v[180:183]
  v_mfma_f32_16x16x32_bf16 v[184:187], v[72:75], v[48:51], v[184:187]
  v_mfma_f32_16x16x32_bf16 v[188:191], v[76:79], v[48:51], v[188:191]
  v_mfma_f32_16x16x32_bf16 v[180:183], v[64:67], v[52:55], v[180:183]
  v_mfma_f32_16x16x32_bf16 v[184:187], v[68:71], v[52:55], v[184:187]
  v_mfma_f32_16x16x32_bf16 v[188:191], v[72:75], v[52:55], v[188:191]
  v_mfma_f32_16x16x32_bf16 v[184:187], v[64:67], v[56:59], v[184:187]
  v_mfma_f32_16x16x32_bf16 v[188:191], v[68:71], v[56:59], v[188:191]
  v_mfma_f32_16x16x32_bf16 v[188:191], v[64:67], v[60:63], v[188:191]
  s_waitcnt lgkmcnt(0)
  v_mfma_f32_16x16x32_bf16 v[160:163], v[128:131], v[96:99], v[160:163]
  ds_read2_b32 v[32:33], v192 offset0:96 offset1:97
  v_mfma_f32_16x16x32_bf16 v[164:167], v[132:135], v[96:99], v[164:167]
  ds_read2_b32 v[34:35], v192 offset0:98 offset1:99
  v_mfma_f32_16x16x32_bf16 v[168:171], v[136:139], v[96:99], v[168:171]
  ds_read_b128 v[64:67], v201 offset:3968
  v_mfma_f32_16x16x32_bf16 v[172:175], v[140:143], v[96:99], v[172:175]
  ds_read2_b32 v[36:37], v193 offset0:96 offset1:97
  v_mfma_f32_16x16x32_bf16 v[176:179], v[144:147], v[96:99], v[176:179]
  ds_read2_b32 v[38:39], v193 offset0:98 offset1:99
  v_mfma_f32_16x16x32_bf16 v[180:183], v[148:151], v[96:99], v[180:183]
  ds_read_b128 v[68:71], v201 offset:3456
  v_mfma_f32_16x16x32_bf16 v[184:187], v[152:155], v[96:99], v[184:187]
  ds_read2_b32 v[40:41], v194 offset0:96 offset1:97
  v_mfma_f32_16x16x32_bf16 v[188:191], v[156:159], v[96:99], v[188:191]
  ds_read2_b32 v[42:43], v194 offset0:98 offset1:99
  v_mfma_f32_16x16x32_bf16 v[164:167], v[128:131], v[100:103], v[164:167]
  ds_read_b128 v[72:75], v201 offset:2944
  v_mfma_f32_16x16x32_bf16 v[168:171], v[132:135], v[100:103], v[168:171]
  ds_read2_b32 v[44:45], v195 offset0:96 offset1:97
  v_mfma_f32_16x16x32_bf16 v[172:175], v[136:139], v[100:103], v[172:175]
  ds_read2_b32 v[46:47], v195 offset0:98 offset1:99
  v_mfma_f32_16x16x32_bf16 v[176:179], v[140:143], v[100:103], v[176:179]
  ds_read_b128 v[76:79], v201 offset:2432
  v_mfma_f32_16x16x32_bf16 v[180:183], v[144:147], v[100:103], v[180:183]
  ds_read2_b32 v[48:49], v196 offset0:96 offset1:97
  v_mfma_f32_16x16x32_bf16 v[184:187], v[148:151], v[100:103], v[184:187]
  ds_read2_b32 v[50:51], v196 offset0:98 offset1:99
  v_mfma_f32_16x16x32_bf16 v[188:191], v[152:155], v[100:103], v[188:191]
  ds_read_b128 v[80:83], v201 offset:1920
  v_mfma_f32_16x16x32_bf16 v[168:171], v[128:131], v[104:107], v[168:171]
  ds_read2_b32 v[52:53], v197 offset0:96 offset1:97
  v_mfma_f32_16x16x32_bf16 v[172:175], v[132:135], v[104:107], v[172:175]
  ds_read2_b32 v[54:55], v197 offset0:98 offset1:99
  v_mfma_f32_16x16x32_bf16 v[176:179], v[136:139], v[104:107], v[176:179]
  ds_read_b128 v[84:87], v201 offset:1408
  v_mfma_f32_16x16x32_bf16 v[180:183], v[140:143], v[104:107], v[180:183]
  ds_read2_b32 v[56:57], v198 offset0:96 offset1:97
  v_mfma_f32_16x16x32_bf16 v[184:187], v[144:147], v[104:107], v[184:187]
  ds_read2_b32 v[58:59], v198 offset0:98 offset1:99
  v_mfma_f32_16x16x32_bf16 v[188:191], v[148:151], v[104:107], v[188:191]
  ds_read_b128 v[88:91], v201 offset:896
  v_mfma_f32_16x16x32_bf16 v[172:175], v[128:131], v[108:111], v[172:175]
  ds_read2_b32 v[60:61], v199 offset0:96 offset1:97
  v_mfma_f32_16x16x32_bf16 v[176:179], v[132:135], v[108:111], v[176:179]
  ds_read2_b32 v[62:63], v199 offset0:98 offset1:99
  v_mfma_f32_16x16x32_bf16 v[180:183], v[136:139], v[108:111], v[180:183]
  ds_read_b128 v[92:95], v201 offset:384
  v_mfma_f32_16x16x32_bf16 v[184:187], v[140:143], v[108:111], v[184:187]
  v_mfma_f32_16x16x32_bf16 v[188:191], v[144:147], v[108:111], v[188:191]
  v_mfma_f32_16x16x32_bf16 v[176:179], v[128:131], v[112:115], v[176:179]
  v_mfma_f32_16x16x32_bf16 v[180:183], v[132:135], v[112:115], v[180:183]
  v_mfma_f32_16x16x32_bf16 v[184:187], v[136:139], v[112:115], v[184:187]
  v_mfma_f32_16x16x32_bf16 v[188:191], v[140:143], v[112:115], v[188:191]
  v_mfma_f32_16x16x32_bf16 v[180:183], v[128:131], v[116:119], v[180:183]
  v_mfma_f32_16x16x32_bf16 v[184:187], v[132:135], v[116:119], v[184:187]
  v_mfma_f32_16x16x32_bf16 v[188:191], v[136:139], v[116:119], v[188:191]
  v_mfma_f32_16x16x32_bf16 v[184:187], v[128:131], v[120:123], v[184:187]
  v_mfma_f32_16x16x32_bf16 v[188:191], v[132:135], v[120:123], v[188:191]
  v_mfma_f32_16x16x32_bf16 v[188:191], v[128:131], v[124:127], v[188:191]
  s_waitcnt lgkmcnt(0)
  v_mfma_f32_16x16x32_bf16 v[160:163], v[64:67], v[32:35], v[160:163]
  ds_read2_b32 v[96:97], v192 offset0:112 offset1:113
  v_mfma_f32_16x16x32_bf16 v[164:167], v[68:71], v[32:35], v[164:167]
  ds_read2_b32 v[98:99], v192 offset0:114 offset1:115
  v_mfma_f32_16x16x32_bf16 v[168:171], v[72:75], v[32:35], v[168:171]
  ds_read_b128 v[128:131], v201 offset:4032
  v_mfma_f32_16x16x32_bf16 v[172:175], v[76:79], v[32:35], v[172:175]
  ds_read2_b32 v[100:101], v193 offset0:112 offset1:113
  v_mfma_f32_16x16x32_bf16 v[176:179], v[80:83], v[32:35], v[176:179]
  ds_read2_b32 v[102:103], v193 offset0:114 offset1:115
  v_mfma_f32_16x16x32_bf16 v[180:183], v[84:87], v[32:35], v[180:183]
  ds_read_b128 v[132:135], v201 offset:3520
  v_mfma_f32_16x16x32_bf16 v[184:187], v[88:91], v[32:35], v[184:187]
  ds_read2_b32 v[104:105], v194 offset0:112 offset1:113
  v_mfma_f32_16x16x32_bf16 v[188:191], v[92:95], v[32:35], v[188:191]
  ds_read2_b32 v[106:107], v194 offset0:114 offset1:115
  v_mfma_f32_16x16x32_bf16 v[164:167], v[64:67], v[36:39], v[164:167]
  ds_read_b128 v[136:139], v201 offset:3008
  v_mfma_f32_16x16x32_bf16 v[168:171], v[68:71], v[36:39], v[168:171]
  ds_read2_b32 v[108:109], v195 offset0:112 offset1:113
  v_mfma_f32_16x16x32_bf16 v[172:175], v[72:75], v[36:39], v[172:175]
  ds_read2_b32 v[110:111], v195 offset0:114 offset1:115
  v_mfma_f32_16x16x32_bf16 v[176:179], v[76:79], v[36:39], v[176:179]
  ds_read_b128 v[140:143], v201 offset:2496
  v_mfma_f32_16x16x32_bf16 v[180:183], v[80:83], v[36:39], v[180:183]
  ds_read2_b32 v[112:113], v196 offset0:112 offset1:113
  v_mfma_f32_16x16x32_bf16 v[184:187], v[84:87], v[36:39], v[184:187]
  ds_read2_b32 v[114:115], v196 offset0:114 offset1:115
  v_mfma_f32_16x16x32_bf16 v[188:191], v[88:91], v[36:39], v[188:191]
  ds_read_b128 v[144:147], v201 offset:1984
  v_mfma_f32_16x16x32_bf16 v[168:171], v[64:67], v[40:43], v[168:171]
  ds_read2_b32 v[116:117], v197 offset0:112 offset1:113
  v_mfma_f32_16x16x32_bf16 v[172:175], v[68:71], v[40:43], v[172:175]
  ds_read2_b32 v[118:119], v197 offset0:114 offset1:115
  v_mfma_f32_16x16x32_bf16 v[176:179], v[72:75], v[40:43], v[176:179]
  ds_read_b128 v[148:151], v201 offset:1472
  v_mfma_f32_16x16x32_bf16 v[180:183], v[76:79], v[40:43], v[180:183]
  ds_read2_b32 v[120:121], v198 offset0:112 offset1:113
  v_mfma_f32_16x16x32_bf16 v[184:187], v[80:83], v[40:43], v[184:187]
  ds_read2_b32 v[122:123], v198 offset0:114 offset1:115
  v_mfma_f32_16x16x32_bf16 v[188:191], v[84:87], v[40:43], v[188:191]
  ds_read_b128 v[152:155], v201 offset:960
  v_mfma_f32_16x16x32_bf16 v[172:175], v[64:67], v[44:47], v[172:175]
  ds_read2_b32 v[124:125], v199 offset0:112 offset1:113
  v_mfma_f32_16x16x32_bf16 v[176:179], v[68:71], v[44:47], v[176:179]
  ds_read2_b32 v[126:127], v199 offset0:114 offset1:115
  v_mfma_f32_16x16x32_bf16 v[180:183], v[72:75], v[44:47], v[180:183]
  ds_read_b128 v[156:159], v201 offset:448
  v_mfma_f32_16x16x32_bf16 v[184:187], v[76:79], v[44:47], v[184:187]
  v_mfma_f32_16x16x32_bf16 v[188:191], v[80:83], v[44:47], v[188:191]
  v_mfma_f32_16x16x32_bf16 v[176:179], v[64:67], v[48:51], v[176:179]
  v_mfma_f32_16x16x32_bf16 v[180:183], v[68:71], v[48:51], v[180:183]
  v_mfma_f32_16x16x32_bf16 v[184:187], v[72:75], v[48:51], v[184:187]
  v_mfma_f32_16x16x32_bf16 v[188:191], v[76:79], v[48:51], v[188:191]
  v_mfma_f32_16x16x32_bf16 v[180:183], v[64:67], v[52:55], v[180:183]
  v_mfma_f32_16x16x32_bf16 v[184:187], v[68:71], v[52:55], v[184:187]
  v_mfma_f32_16x16x32_bf16 v[188:191], v[72:75], v[52:55], v[188:191]
  v_mfma_f32_16x16x32_bf16 v[184:187], v[64:67], v[56:59], v[184:187]
  v_mfma_f32_16x16x32_bf16 v[188:191], v[68:71], v[56:59], v[188:191]
  v_mfma_f32_16x16x32_bf16 v[188:191], v[64:67], v[60:63], v[188:191]
  s_waitcnt lgkmcnt(0)
  v_mfma_f32_16x16x32_bf16 v[160:163], v[128:131], v[96:99], v[160:163]
  v_mfma_f32_16x16x32_bf16 v[164:167], v[132:135], v[96:99], v[164:167]
  v_mfma_f32_16x16x32_bf16 v[168:171], v[136:139], v[96:99], v[168:171]
  v_mfma_f32_16x16x32_bf16 v[172:175], v[140:143], v[96:99], v[172:175]
  v_mfma_f32_16x16x32_bf16 v[176:179], v[144:147], v[96:99], v[176:179]
  v_mfma_f32_16x16x32_bf16 v[180:183], v[148:151], v[96:99], v[180:183]
  v_mfma_f32_16x16x32_bf16 v[184:187], v[152:155], v[96:99], v[184:187]
  v_mfma_f32_16x16x32_bf16 v[188:191], v[156:159], v[96:99], v[188:191]
  v_mfma_f32_16x16x32_bf16 v[164:167], v[128:131], v[100:103], v[164:167]
  v_mfma_f32_16x16x32_bf16 v[168:171], v[132:135], v[100:103], v[168:171]
  v_mfma_f32_16x16x32_bf16 v[172:175], v[136:139], v[100:103], v[172:175]
  v_mfma_f32_16x16x32_bf16 v[176:179], v[140:143], v[100:103], v[176:179]
  v_mfma_f32_16x16x32_bf16 v[180:183], v[144:147], v[100:103], v[180:183]
  v_mfma_f32_16x16x32_bf16 v[184:187], v[148:151], v[100:103], v[184:187]
  v_mfma_f32_16x16x32_bf16 v[188:191], v[152:155], v[100:103], v[188:191]
  v_mfma_f32_16x16x32_bf16 v[168:171], v[128:131], v[104:107], v[168:171]
  v_mfma_f32_16x16x32_bf16 v[172:175], v[132:135], v[104:107], v[172:175]
  v_mfma_f32_16x16x32_bf16 v[176:179], v[136:139], v[104:107], v[176:179]
  v_mfma_f32_16x16x32_bf16 v[180:183], v[140:143], v[104:107], v[180:183]
  v_mfma_f32_16x16x32_bf16 v[184:187], v[144:147], v[104:107], v[184:187]
  v_mfma_f32_16x16x32_bf16 v[188:191], v[148:151], v[104:107], v[188:191]
  v_mfma_f32_16x16x32_bf16 v[172:175], v[128:131], v[108:111], v[172:175]
  v_mfma_f32_16x16x32_bf16 v[176:179], v[132:135], v[108:111], v[176:179]
  v_mfma_f32_16x16x32_bf16 v[180:183], v[136:139], v[108:111], v[180:183]
  v_mfma_f32_16x16x32_bf16 v[184:187], v[140:143], v[108:111], v[184:187]
  v_mfma_f32_16x16x32_bf16 v[188:191], v[144:147], v[108:111], v[188:191]
  v_mfma_f32_16x16x32_bf16 v[176:179], v[128:131], v[112:115], v[176:179]
  v_mfma_f32_16x16x32_bf16 v[180:183], v[132:135], v[112:115], v[180:183]
  v_mfma_f32_16x16x32_bf16 v[184:187], v[136:139], v[112:115], v[184:187]
  v_mfma_f32_16x16x32_bf16 v[188:191], v[140:143], v[112:115], v[188:191]
  v_mfma_f32_16x16x32_bf16 v[180:183], v[128:131], v[116:119], v[180:183]
  v_mfma_f32_16x16x32_bf16 v[184:187], v[132:135], v[116:119], v[184:187]
  v_mfma_f32_16x16x32_bf16 v[188:191], v[136:139], v[116:119], v[188:191]
  v_mfma_f32_16x16x32_bf16 v[184:187], v[128:131], v[120:123], v[184:187]
  v_mfma_f32_16x16x32_bf16 v[188:191], v[132:135], v[120:123], v[188:191]
  v_mfma_f32_16x16x32_bf16 v[188:191], v[128:131], v[124:127], v[188:191]
  s_nop 7
  v_cvt_pk_bf16_f32 v8, v160, v161
  v_cvt_pk_bf16_f32 v9, v162, v163
  ds_write_b32 v5, v8 offset:0
  ds_write_b32 v5, v9 offset:64
  v_cvt_pk_bf16_f32 v10, v164, v165
  v_cvt_pk_bf16_f32 v11, v166, v167
  ds_write_b32 v5, v10 offset:512
  ds_write_b32 v5, v11 offset:576
  v_cvt_pk_bf16_f32 v12, v168, v169
  v_cvt_pk_bf16_f32 v13, v170, v171
  ds_write_b32 v5, v12 offset:1024
  ds_write_b32 v5, v13 offset:1088
  v_cvt_pk_bf16_f32 v14, v172, v173
  v_cvt_pk_bf16_f32 v15, v174, v175
  ds_write_b32 v5, v14 offset:1536
  ds_write_b32 v5, v15 offset:1600
  v_cvt_pk_bf16_f32 v16, v176, v177
  v_cvt_pk_bf16_f32 v17, v178, v179
  ds_write_b32 v5, v16 offset:2048
  ds_write_b32 v5, v17 offset:2112
  v_cvt_pk_bf16_f32 v18, v180, v181
  v_cvt_pk_bf16_f32 v19, v182, v183
  ds_write_b32 v5, v18 offset:2560
  ds_write_b32 v5, v19 offset:2624
  v_cvt_pk_bf16_f32 v20, v184, v185
  v_cvt_pk_bf16_f32 v21, v186, v187
  ds_write_b32 v5, v20 offset:3072
  ds_write_b32 v5, v21 offset:3136
  v_cvt_pk_bf16_f32 v22, v188, v189
  v_cvt_pk_bf16_f32 v23, v190, v191
  ds_write_b32 v5, v22 offset:3584
  ds_write_b32 v5, v23 offset:3648
  s_waitcnt vmcnt(0)
  v_and_b32 v64, s54, v252
  v_lshlrev_b32 v65, 16, v252
  v_lshrrev_b32 v66, 16, v252
  v_and_b32 v67, s7, v252
  v_and_b32 v68, s54, v253
  v_lshlrev_b32 v69, 16, v253
  v_lshrrev_b32 v70, 16, v253
  v_and_b32 v71, s7, v253
  s_mov_b32 s12, 0x3f80
  s_mov_b32 s13, 0x3f800000
  s_branch L_final
L_upost:
  s_waitcnt lgkmcnt(0)
  s_barrier
L_uc0:
  v_and_b32 v60, s54, v132
  v_and_b32 v61, s7, v132
  v_and_b32 v62, s54, v133
  v_and_b32 v63, s7, v133
  v_and_b32 v64, s54, v134
  v_and_b32 v65, s7, v134
  v_and_b32 v66, s54, v135
  v_and_b32 v67, s7, v135
  v_dot2_f32_bf16 v136, v124, v60, 0
  v_dot2_f32_bf16 v137, v124, v61, 0
  v_dot2_f32_bf16 v138, v125, v62, 0
  v_dot2_f32_bf16 v139, v125, v63, 0
  v_dot2_f32_bf16 v140, v126, v64, 0
  v_dot2_f32_bf16 v141, v126, v65, 0
  v_dot2_f32_bf16 v142, v127, v66, 0
  v_dot2_f32_bf16 v143, v127, v67, 0
  v_dot2_f32_bf16 v144, v128, v60, 0
  v_dot2_f32_bf16 v145, v128, v61, 0
  v_dot2_f32_bf16 v146, v129, v62, 0
  v_dot2_f32_bf16 v147, v129, v63, 0
  v_dot2_f32_bf16 v148, v130, v64, 0
  v_dot2_f32_bf16 v149, v130, v65, 0
  v_dot2_f32_bf16 v150, v131, v66, 0
  v_dot2_f32_bf16 v151, v131, v67, 0
  v_cvt_pk_bf16_f32 v152, v136, v137
  v_cvt_pk_bf16_f32 v153, v138, v139
  v_cvt_pk_bf16_f32 v154, v140, v141
  v_cvt_pk_bf16_f32 v155, v142, v143
  v_cvt_pk_bf16_f32 v156, v144, v145
  v_cvt_pk_bf16_f32 v157, v146, v147
  v_cvt_pk_bf16_f32 v158, v148, v149
  v_cvt_pk_bf16_f32 v159, v150, v151
  v_dot2_f32_bf16 v54, v152, s55, 0
  v_dot2_f32_bf16 v55, v156, s55, 0
  v_dot2_f32_bf16 v54, v153, s55, v54
  v_dot2_f32_bf16 v55, v157, s55, v55
  v_dot2_f32_bf16 v54, v154, s55, v54
  v_dot2_f32_bf16 v55, v158, s55, v55
  v_dot2_f32_bf16 v54, v155, s55, v54
  v_dot2_f32_bf16 v55, v159, s55, v55
  s_nop 2
  v_add_f32_dpp v54, v54, v54 row_shr:1 row_mask:0xf bank_mask:0xf bound_ctrl:0
  v_add_f32_dpp v55, v55, v55 row_shr:1 row_mask:0xf bank_mask:0xf bound_ctrl:0
  s_nop 0
  v_add_f32_dpp v54, v54, v54 row_shr:2 row_mask:0xf bank_mask:0xf bound_ctrl:0
  v_add_f32_dpp v55, v55, v55 row_shr:2 row_mask:0xf bank_mask:0xf bound_ctrl:0
  s_nop 0
  v_add_f32_dpp v54, v54, v54 row_shr:4 row_mask:0xf bank_mask:0xf bound_ctrl:0
  v_add_f32_dpp v55, v55, v55 row_shr:4 row_mask:0xf bank_mask:0xf bound_ctrl:0
  s_nop 0
  v_add_f32_dpp v54, v54, v54 row_shr:8 row_mask:0xf bank_mask:0xf bound_ctrl:0
  v_add_f32_dpp v55, v55, v55 row_shr:8 row_mask:0xf bank_mask:0xf bound_ctrl:0
  s_nop 0
  v_add_f32_dpp v54, v54, v54 row_bcast:15 row_mask:0xa bank_mask:0xf
  v_add_f32_dpp v55, v55, v55 row_bcast:15 row_mask:0xa bank_mask:0xf
  s_nop 0
  v_add_f32_dpp v54, v54, v54 row_bcast:31 row_mask:0xc bank_mask:0xf
  v_add_f32_dpp v55, v55, v55 row_bcast:31 row_mask:0xc bank_mask:0xf
  v_cvt_pk_bf16_f32 v56, v54, v55
  v_lshlrev_b32 v54, 16, v56
  v_and_b32 v55, s7, v56
  v_mul_f32 v54, 0xbfb8aa3b, v54
  v_mul_f32 v55, 0xbfb8aa3b, v55
  v_exp_f32 v54, v54
  v_exp_f32 v55, v55
  s_nop 0
  v_add_f32 v54, 1.0, v54
  v_add_f32 v55, 1.0, v55
  v_rcp_f32 v54, v54
  v_rcp_f32 v55, v55
  s_nop 0
  v_cvt_pk_bf16_f32 v56, v54, v55
  v_lshlrev_b32 v54, 16, v56
  v_and_b32 v55, s7, v56
  v_sub_f32 v56, 1.0, v54
  v_sub_f32 v57, 1.0, v55
  v_cvt_pk_bf16_f32 v58, v54, v56
  v_cvt_pk_bf16_f32 v59, v55, v57
  s_cbranch_execz L_warm_ret
  s_lshl_b32 s8, s35, 2
  s_add_u32 s8, s8, 0x600000
  v_mov_b32 v53, s8
  s_mov_b32 exec_lo, 0
  s_mov_b32 exec_hi, 0x80000000
  global_store_dwordx2 v53, v[58:59], s[52:53] sc1
  s_mov_b64 exec, -1
  v_mov_b32 v48, 24592
  v_mov_b32 v49, 1
  s_lshr_b32 s8, s4, 1
  s_lshl_b32 s8, s8, 6
  s_and_b32 s9, s4, 1
  s_lshl_b32 s9, s9, 4
  s_add_u32 s8, s8, s9
  s_add_u32 s8, s8, 4
  v_mov_b32 v50, s8
  s_waitcnt vmcnt(0)
  s_mov_b64 exec, 1
  ds_add_rtn_u32 v52, v48, v49
  s_waitcnt lgkmcnt(0)
  v_cmp_eq_u32 vcc, 3, v52
  s_and_b64 exec, exec, vcc
  s_cbranch_execz L_garr_done
  global_atomic_add v53, v50, v49, s[50:51] sc0 sc1
  s_waitcnt vmcnt(0)
  v_and_b32 v53, 31, v53
  v_cmp_eq_u32 vcc, 31, v53
  s_and_b64 exec, exec, vcc
  s_cbranch_execz L_garr_done
  s_mov_b64 exec, -1
  v_lshlrev_b32 v52, 7, v1
  v_add_u32 v52, 0x700004, v52
  global_atomic_add v52, v49, s[52:53] sc1
  v_add_u32 v52, 8192, v52
  global_atomic_add v52, v49, s[52:53] sc1
  v_add_u32 v52, 8192, v52
  global_atomic_add v52, v49, s[52:53] sc1
  v_add_u32 v52, 8192, v52
  global_atomic_add v52, v49, s[52:53] sc1
L_garr_done:
  s_mov_b64 exec, -1
  s_cmp_lg_u32 s3, 4
  s_cbranch_scc1 L_uwait
  v_mov_b32 v10, 24584
  ds_read_b32 v11, v10
  s_lshl_b32 s8, s2, 7
  s_add_u32 s8, s8, 0x700004
  v_mov_b32 v10, s8
  s_waitcnt lgkmcnt(0)
  s_mov_b32 s58, 0
  s_mov_b64 exec, 1
  global_load_dword v9, v10, s[52:53] sc1
  s_sleep 1
  global_load_dword v14, v10, s[52:53] sc1
  s_sleep 1
  global_load_dword v15, v10, s[52:53] sc1
  s_sleep 1
L_pollG:
  global_load_dword v16, v10, s[52:53] sc1
  s_waitcnt vmcnt(3)
  v_cmp_ne_u32 vcc, v11, v9
  s_add_u32 s58, s58, 1
  s_nop 0
  s_cbranch_vccz L_pollG_done
  s_sleep 1
  global_load_dword v9, v10, s[52:53] sc1
  s_waitcnt vmcnt(3)
  v_cmp_ne_u32 vcc, v11, v14
  s_add_u32 s58, s58, 1
  s_nop 0
  s_cbranch_vccz L_pollG_done
  s_sleep 1
  global_load_dword v14, v10, s[52:53] sc1
  s_waitcnt vmcnt(3)
  v_cmp_ne_u32 vcc, v11, v15
  s_add_u32 s58, s58, 1
  s_nop 0
  s_cbranch_vccz L_pollG_done
  s_sleep 1
  global_load_dword v15, v10, s[52:53] sc1
  s_waitcnt vmcnt(3)
  v_cmp_ne_u32 vcc, v11, v16
  s_add_u32 s58, s58, 1
  s_nop 0
  s_cbranch_vccz L_pollG_done
  s_sleep 1
  s_cmp_lt_u32 s58, 262144
  s_cbranch_scc1 L_pollG
L_pollG_done:
  s_waitcnt vmcnt(0)
  s_mov_b64 exec, -1
  v_lshlrev_b32 v40, 4, v1
  v_add_u32 v41, 0x600000, v40
  v_add_u32 v42, 4096, v41
  global_load_dwordx4 v[72:75], v41, s[52:53] offset:0 sc1
  global_load_dwordx4 v[76:79], v41, s[52:53] offset:1024 sc1
  global_load_dwordx4 v[80:83], v41, s[52:53] offset:2048 sc1
  global_load_dwordx4 v[84:87], v41, s[52:53] offset:3072 sc1
  global_load_dwordx4 v[88:91], v42, s[52:53] offset:0 sc1
  global_load_dwordx4 v[92:95], v42, s[52:53] offset:1024 sc1
  global_load_dwordx4 v[96:99], v42, s[52:53] offset:2048 sc1
  global_load_dwordx4 v[100:103], v42, s[52:53] offset:3072 sc1
  s_waitcnt vmcnt(7)
  ds_write_b128 v40, v[72:75] offset:28800
  s_waitcnt vmcnt(6)
  ds_write_b128 v40, v[76:79] offset:29824
  s_waitcnt vmcnt(5)
  ds_write_b128 v40, v[80:83] offset:30848
  s_waitcnt vmcnt(4)
  ds_write_b128 v40, v[84:87] offset:31872
  s_waitcnt vmcnt(3)
  ds_write_b128 v40, v[88:91] offset:32896
  s_waitcnt vmcnt(2)
  ds_write_b128 v40, v[92:95] offset:33920
  s_waitcnt vmcnt(1)
  ds_write_b128 v40, v[96:99] offset:34944
  s_waitcnt vmcnt(0)
  ds_write_b128 v40, v[100:103] offset:35968
  v_mov_b32 v10, 24588
  v_mov_b32 v11, 1
  s_waitcnt lgkmcnt(0)
  ds_write_b32 v10, v11
L_uwait:
  s_waitcnt vmcnt(0)
  v_and_b32 v64, s54, v252
  v_lshlrev_b32 v65, 16, v252
  v_lshrrev_b32 v66, 16, v252
  v_and_b32 v67, s7, v252
  v_and_b32 v68, s54, v253
  v_lshlrev_b32 v69, 16, v253
  v_lshrrev_b32 v70, 16, v253
  v_and_b32 v71, s7, v253
  s_mov_b32 s12, 0x3f80
  s_mov_b32 s13, 0x3f800000
L_final:
  s_waitcnt lgkmcnt(0)
  s_barrier
  v_lshlrev_b32 v5, 3, v0
  v_sub_u32 v6, 57464, v5
  v_lshlrev_b32 v4, 4, v0
  v_lshlrev_b32 v7, 12, v0
  s_lshl_b32 s8, s6, 1
  s_add_u32 s8, s8, 0
  v_add_u32 v7, s8, v7
  ds_read_b64 v[32:33], v5 offset:36992
  ds_read_b64 v[34:35], v5 offset:41088
  ds_read_b64 v[36:37], v5 offset:45184
  ds_read_b64 v[38:39], v5 offset:49280
  ds_read_b64 v[40:41], v6 offset:0
  ds_read_b64 v[42:43], v6 offset:9216
  ds_read_b64 v[44:45], v6 offset:18432
  ds_read_b64 v[46:47], v6 offset:27648
  ds_read_b128 v[48:51], v4 offset:28800
  s_waitcnt lgkmcnt(0)
  v_dot2_f32_bf16 v72, v41, v65, 0
  v_dot2_f32_bf16 v80, v43, v69, 0
  v_dot2_f32_bf16 v88, v32, s12, 0
  v_dot2_f32_bf16 v96, v34, s12, 0
  v_and_b32 v112, s7, v41
  v_dot2_f32_bf16 v73, v45, v67, 0
  v_dot2_f32_bf16 v81, v47, v71, 0
  v_dot2_f32_bf16 v89, v36, s12, 0
  v_dot2_f32_bf16 v97, v38, s12, 0
  v_and_b32 v113, s7, v45
  v_dot2_f32_bf16 v74, v41, v64, 0
  v_dot2_f32_bf16 v82, v43, v68, 0
  v_dot2_f32_bf16 v90, v32, s13, 0
  v_dot2_f32_bf16 v98, v34, s13, 0
  v_lshlrev_b32 v114, 16, v41
  v_dot2_f32_bf16 v75, v45, v66, 0
  v_dot2_f32_bf16 v83, v47, v70, 0
  v_dot2_f32_bf16 v91, v36, s13, 0
  v_dot2_f32_bf16 v99, v38, s13, 0
  v_lshlrev_b32 v115, 16, v45
  v_dot2_f32_bf16 v76, v40, v65, 0
  v_dot2_f32_bf16 v84, v42, v69, 0
  v_dot2_f32_bf16 v92, v33, s12, 0
  v_dot2_f32_bf16 v100, v35, s12, 0
  v_and_b32 v116, s7, v40
  v_dot2_f32_bf16 v77, v44, v67, 0
  v_dot2_f32_bf16 v85, v46, v71, 0
  v_dot2_f32_bf16 v93, v37, s12, 0
  v_dot2_f32_bf16 v101, v39, s12, 0
  v_and_b32 v117, s7, v44
  v_dot2_f32_bf16 v78, v40, v64, 0
  v_dot2_f32_bf16 v86, v42, v68, 0
  v_dot2_f32_bf16 v94, v33, s13, 0
  v_dot2_f32_bf16 v102, v35, s13, 0
  v_lshlrev_b32 v118, 16, v40
  v_dot2_f32_bf16 v79, v44, v66, 0
  v_dot2_f32_bf16 v87, v46, v70, 0
  v_dot2_f32_bf16 v95, v37, s13, 0
  v_dot2_f32_bf16 v103, v39, s13, 0
  v_lshlrev_b32 v119, 16, v44
  v_cvt_pk_bf16_f32 v104, v72, v80
  v_cvt_pk_bf16_f32 v105, v73, v81
  v_cvt_pk_bf16_f32 v106, v74, v82
  v_cvt_pk_bf16_f32 v107, v75, v83
  v_cvt_pk_bf16_f32 v108, v76, v84
  v_cvt_pk_bf16_f32 v109, v77, v85
  v_cvt_pk_bf16_f32 v110, v78, v86
  v_cvt_pk_bf16_f32 v111, v79, v87
  v_dot2_f32_bf16 v72, v104, s12, v88
  v_dot2_f32_bf16 v80, v104, s13, v96
  v_dot2_f32_bf16 v73, v105, s12, v89
  v_dot2_f32_bf16 v81, v105, s13, v97
  v_dot2_f32_bf16 v74, v106, s12, v90
  v_dot2_f32_bf16 v82, v106, s13, v98
  v_dot2_f32_bf16 v75, v107, s12, v91
  v_dot2_f32_bf16 v83, v107, s13, v99
  v_dot2_f32_bf16 v76, v108, s12, v92
  v_dot2_f32_bf16 v84, v108, s13, v100
  v_dot2_f32_bf16 v77, v109, s12, v93
  v_dot2_f32_bf16 v85, v109, s13, v101
  v_dot2_f32_bf16 v78, v110, s12, v94
  v_dot2_f32_bf16 v86, v110, s13, v102
  v_dot2_f32_bf16 v79, v111, s12, v95
  v_dot2_f32_bf16 v87, v111, s13, v103
  v_and_b32 v120, s54, v48
  v_and_b32 v124, s7, v48
  v_and_b32 v121, s54, v49
  v_and_b32 v125, s7, v49
  v_and_b32 v122, s54, v50
  v_and_b32 v126, s7, v50
  v_and_b32 v123, s54, v51
  v_and_b32 v127, s7, v51
  v_cvt_pk_bf16_f32 v104, v72, v80
  v_cvt_pk_bf16_f32 v105, v73, v81
  v_cvt_pk_bf16_f32 v106, v74, v82
  v_cvt_pk_bf16_f32 v107, v75, v83
  v_cvt_pk_bf16_f32 v108, v76, v84
  v_cvt_pk_bf16_f32 v109, v77, v85
  v_cvt_pk_bf16_f32 v110, v78, v86
  v_cvt_pk_bf16_f32 v111, v79, v87
  v_dot2_f32_bf16 v72, v104, v120, 0
  v_dot2_f32_bf16 v80, v104, v112, 0
  v_dot2_f32_bf16 v73, v105, v120, 0
  v_dot2_f32_bf16 v81, v105, v113, 0
  v_dot2_f32_bf16 v74, v106, v121, 0
  v_dot2_f32_bf16 v82, v106, v114, 0
  v_dot2_f32_bf16 v75, v107, v121, 0
  v_dot2_f32_bf16 v83, v107, v115, 0
  v_dot2_f32_bf16 v76, v108, v122, 0
  v_dot2_f32_bf16 v84, v108, v116, 0
  v_dot2_f32_bf16 v77, v109, v122, 0
  v_dot2_f32_bf16 v85, v109, v117, 0
  v_dot2_f32_bf16 v78, v110, v123, 0
  v_dot2_f32_bf16 v86, v110, v118, 0
  v_dot2_f32_bf16 v79, v111, v123, 0
  v_dot2_f32_bf16 v87, v111, v119, 0
  v_cvt_pk_bf16_f32 v104, v72, v80
  v_cvt_pk_bf16_f32 v105, v73, v81
  v_cvt_pk_bf16_f32 v106, v74, v82
  v_cvt_pk_bf16_f32 v107, v75, v83
  v_cvt_pk_bf16_f32 v108, v76, v84
  v_cvt_pk_bf16_f32 v109, v77, v85
  v_cvt_pk_bf16_f32 v110, v78, v86
  v_cvt_pk_bf16_f32 v111, v79, v87
  v_dot2_f32_bf16 v80, v104, v124, 0
  v_dot2_f32_bf16 v81, v105, v124, 0
  v_dot2_f32_bf16 v82, v106, v125, 0
  v_dot2_f32_bf16 v83, v107, v125, 0
  v_dot2_f32_bf16 v84, v108, v126, 0
  v_dot2_f32_bf16 v85, v109, v126, 0
  v_dot2_f32_bf16 v86, v110, v127, 0
  v_dot2_f32_bf16 v87, v111, v127, 0
  v_cvt_pk_bf16_f32 v104, v72, v80
  v_cvt_pk_bf16_f32 v105, v73, v81
  v_cvt_pk_bf16_f32 v106, v74, v82
  v_cvt_pk_bf16_f32 v107, v75, v83
  v_cvt_pk_bf16_f32 v108, v76, v84
  v_cvt_pk_bf16_f32 v109, v77, v85
  v_cvt_pk_bf16_f32 v110, v78, v86
  v_cvt_pk_bf16_f32 v111, v79, v87
  v_dot2_f32_bf16 v72, v104, s55, 0
  v_dot2_f32_bf16 v73, v105, s55, 0
  v_dot2_f32_bf16 v74, v106, s55, 0
  v_dot2_f32_bf16 v75, v107, s55, 0
  v_dot2_f32_bf16 v76, v108, s55, 0
  v_dot2_f32_bf16 v77, v109, s55, 0
  v_dot2_f32_bf16 v78, v110, s55, 0
  v_dot2_f32_bf16 v79, v111, s55, 0
  s_nop 2
  v_cvt_pk_bf16_f32 v80, v72, v73
  global_store_dword v7, v80, s[48:49] offset:0
  v_cvt_pk_bf16_f32 v81, v74, v75
  global_store_dword v7, v81, s[48:49] offset:1024
  v_cvt_pk_bf16_f32 v82, v76, v77
  global_store_dword v7, v82, s[48:49] offset:2048
  v_cvt_pk_bf16_f32 v83, v78, v79
  global_store_dword v7, v83, s[48:49] offset:3072
L_end:
  s_endpgm
.section .rodata,"a"
.p2align 6
.amdhsa_kernel gated_mix__ssm_conv_s4__ssm_conv_h3__prompt_kernel
  .amdhsa_next_free_vgpr 256
  .amdhsa_next_free_sgpr 102
  .amdhsa_accum_offset 256
  .amdhsa_group_segment_fixed_size 0
  .amdhsa_kernarg_size 152
  .amdhsa_user_sgpr_count 2
  .amdhsa_user_sgpr_kernarg_segment_ptr 1
  .amdhsa_system_sgpr_workgroup_id_x 1
.end_amdhsa_kernel
```
